```python
import torch

def _softmax(x, axis=-1):
    return torch.softmax(x, dim=axis)
def _gelu(x):
    return torch.nn.functional.gelu(x, approximate="tanh")
def _silu(x):
    return torch.nn.functional.silu(x)
def _sigmoid(x):
    return torch.sigmoid(x)
def _layernorm(x, axis=-1, eps=1e-5):
    m = x.mean(dim=axis, keepdim=True)
    v = x.var(dim=axis, keepdim=True, unbiased=False)
    return (x - m) / torch.sqrt(v + eps)
def _scatter_add(tgt, idx, src, axis=0):
    return tgt.clone().index_add_(axis, idx, src)
def _segment_sum(src, seg, n):
    out = torch.zeros((n,) + src.shape[1:], dtype=src.dtype)
    return out.index_add_(0, seg, src)
def _pad(x, pw):
    flat = tuple(v for pair in reversed(pw) for v in pair)
    return torch.nn.functional.pad(x, flat)

kernel_name = 'gated_mix__grouped_kv_mqa__moe_arch_mod__prompt'

def setup_inputs():

    _w = (lambda a: (lambda t: t.to(torch.bfloat16) if t.is_floating_point() else t)(torch.as_tensor(a)))
    def _A_setup():
        B, S, D, H = 1, 2048, 512, 32
        Dh = D // H
        return {
            "x": _w((lambda *s: torch.randn(*s, dtype=torch.bfloat16) * 0.05)(B, S, D)),
            "wq": _w((lambda *s: torch.randn(*s, dtype=torch.bfloat16) * 1.6)(D, H * Dh)),
            "wk": _w((lambda *s: torch.randn(*s, dtype=torch.bfloat16) * 1.6)(D, Dh)),
            "wv": _w((lambda *s: torch.randn(*s, dtype=torch.bfloat16) * 0.1)(D, Dh)),
            "wo": _w((lambda *s: torch.randn(*s, dtype=torch.bfloat16) * 0.1)(H * Dh, D)),
        }
    _A_in = _A_setup()

    def _B_setup():
        B, S, D, F, C = 1, 2048, 512, 1792, 1
        return {
            "x": _w((lambda *s: torch.randn(*s, dtype=torch.bfloat16) * 0.05)(B, S, D)),
            "w_r": _w((lambda *s: torch.randn(*s, dtype=torch.bfloat16) * 3.2)(D)),
            "w_gate": _w((lambda *s: torch.randn(*s, dtype=torch.bfloat16) * 0.2)(D, F)),
            "w_up": _w((lambda *s: torch.randn(*s, dtype=torch.bfloat16) * 0.2)(D, F)),
            "w_down": _w((lambda *s: torch.randn(*s, dtype=torch.bfloat16) * 0.2)(F, D)),
        }
    _B_in = _B_setup()

    return {
        "A_x": _A_in["x"],
        "A_wq": _A_in["wq"],
        "A_wk": _A_in["wk"],
        "A_wv": _A_in["wv"],
        "A_wo": _A_in["wo"],
        "B_x": _B_in["x"],
        "B_w_r": _B_in["w_r"],
        "B_w_gate": _B_in["w_gate"],
        "B_w_up": _B_in["w_up"],
        "B_w_down": _B_in["w_down"],
        "gate_w": _w((lambda *s: torch.randn(*s, dtype=torch.bfloat16) * 0.05)(512) * 16.0),
    }

def reference(A_x, A_wq, A_wk, A_wv, A_wo, B_x, B_w_r, B_w_gate, B_w_up, B_w_down, gate_w):
    def _A_ref(x, wq, wk, wv, wo):
        B, S, D = x.shape
        H = 32
        Dh = D // H
        q = (lambda x, *d: x.permute(*d))((x @ wq).reshape(B, S, H, Dh), 0, 2, 1, 3)
        k = x @ wk
        v = x @ wv
        scores = torch.einsum("bhqd,bkd->bhqk", q, k) * (Dh ** -0.5)
        p = _softmax(scores, axis=-1)
        o = torch.einsum("bhqk,bkd->bhqd", p, v)
        return (lambda x, *d: x.permute(*d))(o, 0, 2, 1, 3).reshape(B, S, H * Dh) @ wo

    def _B_ref(x, w_r, w_gate, w_up, w_down):
        B, S, D = x.shape
        C = 1
        r = x @ w_r
        idx = torch.argsort(-r, axis=-1)[:, :C]
        idx_e = (lambda x, n, axis: torch.repeat_interleave(x, n, dim=axis))(idx.reshape(B, C, 1), D, axis=2)
        x_sel = (lambda x, i, axis: torch.take_along_dim(x, i, dim=axis))(x, idx_e, axis=1)
        g = _silu(x_sel @ w_gate)
        u = x_sel @ w_up
        y = (g * u) @ w_down
        r_sel = _sigmoid((lambda x, i, axis: torch.take_along_dim(x, i, dim=axis))(r, idx, axis=1))
        y = y * r_sel.reshape(B, C, 1)
        b_off = (torch.arange(B) * S).reshape(B, 1)
        flat_idx = (idx + b_off).reshape(B * C)
        zero = (x * 0.0).reshape(B * S, D)
        upd = _scatter_add(zero, flat_idx, y.reshape(B * C, D), axis=0)
        return x + upd.reshape(B, S, D)

    x = A_x
    g = _sigmoid((x * gate_w).sum(-1, keepdims=True))
    a = _A_ref(x, A_wq, A_wk, A_wv, A_wo)
    b = _B_ref(x, B_w_r, B_w_gate, B_w_up, B_w_down)
    return g * a + (1 - g) * b
```

```asm
; @launch grid=(256,1,1) block=(512,1,1) lds=163840
.amdgcn_target "amdgcn-amd-amdhsa--gfx950"
.text
.globl gated_mix__grouped_kv_mqa__moe_arch_mod__prompt_kernel
.p2align 12
.fill 832, 4, 0xbf800000
.p2align 8
.type gated_mix__grouped_kv_mqa__moe_arch_mod__prompt_kernel,@function
gated_mix__grouped_kv_mqa__moe_arch_mod__prompt_kernel:
    s_cmp_ge_u32 s2, 256
    s_cbranch_scc1 L_end
    s_load_dwordx16 s[16:31], s[0:1], 0
    s_load_dwordx8 s[32:39], s[0:1], 64
    s_load_dwordx4 s[40:43], s[0:1], 96
    v_and_b32 v1, 63, v0
    v_lshrrev_b32 v6, 6, v0
    v_and_b32 v2, 15, v0
    v_readfirstlane_b32 s3, v6
    v_lshrrev_b32 v3, 4, v1
    v_lshlrev_b32 v5, 4, v1
    v_lshlrev_b32 v4, 2, v1
    s_getpc_b64 s[64:65]
L_pc:
    s_lshr_b32 s6, s2, 3
    s_lshl_b32 s6, s6, 10
    s_min_u32 s6, s6, L_code_end-L_pc-1024
    v_add_u32 v9, s6, v5
    s_cmp_eq_u32 s3, 7
    s_cbranch_scc0 L_nocpf
    global_load_dwordx4 v[48:51], v9, s[64:65]
L_nocpf:
    s_and_b32 s6, s2, 7
    s_lshr_b32 s5, s2, 5
    s_bfe_u32 s7, s2, 0x20003
    s_lshl_b32 s4, s6, 2
    s_add_u32 s4, s4, s7
    s_mov_b32 s14, s7
    s_and_b32 s80, s5, 1
    s_lshr_b32 s81, s3, 2
    s_xor_b32 s81, s81, s80
    s_bfe_u32 s69, s5, 0x10001
    s_lshl_b32 s15, s80, 1
    s_add_u32 s15, s15, s69
    s_xor_b32 s15, s15, s3
    s_lshl_b32 s15, s15, 14
    s_lshl_b32 s12, s4, 16
    s_lshl_b32 s7, s14, 8
    v_xor_b32 v11, s7, v5
    v_and_b32 v6, 16, v1
    v_lshlrev_b32 v6, 3, v6
    v_xor_b32 v21, v6, v5
    s_mov_b32 s46, 2097152
    s_mov_b32 s47, 0x20000
    s_mov_b32 s50, 524288
    s_mov_b32 s51, 0x20000
    s_mov_b32 s74, 16384
    s_mov_b32 s75, 0x20000
    s_mov_b32 s58, 1024
    s_mov_b32 s59, 0x20000
    s_lshl_b32 s6, s3, 14
    s_xor_b32 s6, s6, s15
    s_lshl_b32 s7, s3, 12
    s_add_u32 s83, s6, s7
    s_add_u32 s11, s83, s12
    s_lshl_b32 s8, s3, 6
    v_xor_b32 v12, s8, v11
    v_xor_b32 v13, 16, v12
    v_xor_b32 v14, 32, v12
    v_xor_b32 v15, 48, v12
    s_lshl_b32 s8, s14, 12
    s_xor_b32 s8, s8, s7
    s_add_u32 s7, s7, 131072
    v_mov_b32 v53, 161920
    v_mov_b32 v19, 0
    ds_write_b32 v53, v19 offset:4
    s_mov_b32 m0, s83
    s_waitcnt lgkmcnt(0)
    s_mov_b32 s44, s16
    s_mov_b32 s45, s17
    s_mov_b32 s48, s18
    s_mov_b32 s49, s19
    s_cmp_ge_u32 s5, 4
    s_cselect_b32 s72, s22, s20
    s_cselect_b32 s73, s23, s21
    s_cmp_ge_u32 s3, 4
    s_cbranch_scc1 L_p1hi
    buffer_load_dwordx4 v12, s[44:47], s11 offen lds
    buffer_load_dwordx4 v13, s[44:47], s11 offen offset:1024 lds
    buffer_load_dwordx4 v14, s[44:47], s11 offen offset:2048 lds
    buffer_load_dwordx4 v15, s[44:47], s11 offen offset:3072 lds
    s_mov_b32 m0, s7
    s_load_dword s68, s[42:43], 327680
    buffer_load_dwordx4 v21, s[72:75], s8 offen lds
    buffer_load_dwordx4 v21, s[72:75], s8 offen offset:1024 lds
    buffer_load_dwordx4 v21, s[72:75], s8 offen offset:2048 lds
    buffer_load_dwordx4 v21, s[72:75], s8 offen offset:3072 lds
    s_cmp_ge_u32 s3, 2
    s_cbranch_scc1 L_p1end
    s_lshl_b32 s6, s3, 10
    s_add_u32 m0, s6, 159744
    s_cmp_eq_u32 s3, 1
    s_cselect_b32 s56, s36, s28
    s_cselect_b32 s57, s37, s29
    buffer_load_dwordx4 v11, s[56:59], 0 offen lds
L_p1end:
    s_barrier
    s_branch L_setup
L_p1hi:
    s_barrier
L_setup:
    s_and_b32 s9, s3, 3
    s_and_b32 s6, s3, 1
    s_lshl_b32 s8, s9, 13
    s_lshl_b32 s7, s6, 2
    v_and_b32 v6, 1, v3
    v_lshlrev_b32 v6, 1, v6
    v_or_b32 v6, s7, v6
    v_and_b32 v7, 7, v1
    v_xor_b32 v6, v6, v7
    v_lshlrev_b32 v6, 4, v6
    v_lshrrev_b32 v7, 3, v1
    v_lshl_add_u32 v6, v7, 10, v6
    s_lshl_b32 s7, s5, 7
    s_add_u32 s7, s7, s8
    v_add_u32 v10, s7, v6
    s_lshl_b32 s10, s9, 10
    s_add_u32 s10, s10, 65536
    s_lshl_b32 s78, s14, 17
    s_and_b32 s6, s2, 7
    s_mov_b32 s7, s14
    s_lshl_b32 s8, s7, 3
    s_add_u32 s8, s8, s6
    s_cmp_lt_u32 s8, 28
    s_cselect_b32 s77, 1, 0
    s_lshl_b32 s8, s8, 6
    s_lshl_b32 s7, s5, 3
    s_add_u32 s76, s8, s7
    s_lshl_b32 s82, s4, 1
    s_add_u32 s82, s82, s80
    s_lshl_b32 s70, s4, 3
    s_add_u32 s70, s70, s5
    s_mov_b32 s13, 0
    s_mov_b32 s60, s42
    s_mov_b32 s61, s43
    s_mov_b32 s62, 8388608
    s_mov_b32 s63, 0x20000
    v_lshlrev_b32 v8, 2, v2
    v_add_u32 v8, 161792, v8
    ds_write_b32 v8, v19
    ds_write_b32 v8, v19 offset:1024
    ds_write_b32 v8, v19 offset:1088
    v_lshl_or_b32 v24, s3, 6, v1
    v_mov_b32 v22, 0
    v_mov_b32 v23, 0
    v_lshlrev_b32 v24, 3, v24
    v_add_u32 v24, 155648, v24
    ds_write_b64 v24, v[22:23]
    s_mov_b32 s52, s24
    s_mov_b32 s53, s25
    s_mov_b32 s54, 524288
    s_mov_b32 s55, 0x20000
    s_mov_b32 s64, s38
    s_mov_b32 s65, s39
    s_mov_b32 s66, 2097152
    s_mov_b32 s67, 0x20000
    v_and_b32 v6, 11, v2
    v_cmp_eq_u32 vcc, 0, v6
    v_mov_b32 v7, 0x3f803f80
    s_nop 0
    v_cndmask_b32 v192, 0, v7, vcc
    v_mov_b32 v193, v192
    v_mov_b32 v194, v192
    v_mov_b32 v195, v192
    v_mov_b32 v196, v192
    v_mov_b32 v197, v192
    v_mov_b32 v198, v192
    v_mov_b32 v199, v192
    v_mov_b32 v200, v192
    v_mov_b32 v201, v192
    v_mov_b32 v202, v192
    v_mov_b32 v203, v192
    v_mov_b32 v204, v192
    v_mov_b32 v205, v192
    v_mov_b32 v206, v192
    v_mov_b32 v207, v192
    v_mov_b32 v208, v192
    v_mov_b32 v209, v192
    v_mov_b32 v210, v192
    v_mov_b32 v211, v192
    v_mov_b32 v212, v192
    v_mov_b32 v213, v192
    v_mov_b32 v214, v192
    v_mov_b32 v215, v192
    v_mov_b32 v216, v192
    v_mov_b32 v217, v192
    v_mov_b32 v218, v192
    v_mov_b32 v219, v192
    v_mov_b32 v220, v192
    v_mov_b32 v221, v192
    v_mov_b32 v222, v192
    v_mov_b32 v223, v192
    s_and_b32 s6, s3, 3
    s_lshr_b32 s7, s3, 2
    v_lshlrev_b32 v6, 3, v1
    s_add_u32 s8, s6, 0
    s_and_b32 s8, s8, 3
    s_lshl_b32 s9, s7, 2
    s_add_u32 s8, s8, s9
    s_lshl_b32 s9, s8, 11
    s_add_u32 s9, s9, 139264
    v_add_u32 v54, s9, v5
    s_lshl_b32 s9, s8, 9
    s_add_u32 s9, s9, 155648
    v_add_u32 v59, s9, v6
    s_add_u32 s8, s6, 1
    s_and_b32 s8, s8, 3
    s_lshl_b32 s9, s7, 2
    s_add_u32 s8, s8, s9
    s_lshl_b32 s9, s8, 11
    s_add_u32 s9, s9, 139264
    v_add_u32 v55, s9, v5
    s_lshl_b32 s9, s8, 9
    s_add_u32 s9, s9, 155648
    v_add_u32 v60, s9, v6
    s_add_u32 s8, s6, 2
    s_and_b32 s8, s8, 3
    s_lshl_b32 s9, s7, 2
    s_add_u32 s8, s8, s9
    s_lshl_b32 s9, s8, 11
    s_add_u32 s9, s9, 139264
    v_add_u32 v56, s9, v5
    s_lshl_b32 s9, s8, 9
    s_add_u32 s9, s9, 155648
    v_add_u32 v61, s9, v6
    s_add_u32 s8, s6, 3
    s_and_b32 s8, s8, 3
    s_lshl_b32 s9, s7, 2
    s_add_u32 s8, s8, s9
    s_lshl_b32 s9, s8, 11
    s_add_u32 s9, s9, 139264
    v_add_u32 v57, s9, v5
    s_lshl_b32 s9, s8, 9
    s_add_u32 s9, s9, 155648
    v_add_u32 v62, s9, v6
    s_add_u32 s8, s6, 2
    s_and_b32 s8, s8, 3
    s_xor_b32 s9, s7, 1
    s_lshl_b32 s9, s9, 2
    s_add_u32 s8, s8, s9
    s_lshl_b32 s9, s8, 11
    s_add_u32 s9, s9, 139264
    v_add_u32 v58, s9, v5
    s_lshl_b32 s9, s8, 9
    s_add_u32 s9, s9, 155648
    v_add_u32 v63, s9, v6
    s_lshl_b32 s6, s6, 1
    s_xor_b32 s8, s7, 0
    s_add_u32 s8, s8, s6
    s_and_b32 s8, s8, 7
    s_lshl_b32 s8, s8, 10
    s_add_u32 s8, s8, 131072
    v_add_u32 v252, s8, v5
    s_xor_b32 s8, s7, 1
    s_add_u32 s8, s8, s6
    s_and_b32 s8, s8, 7
    s_lshl_b32 s8, s8, 10
    s_add_u32 s8, s8, 131072
    v_add_u32 v253, s8, v5
    s_xor_b32 s8, s7, 2
    s_add_u32 s8, s8, s6
    s_and_b32 s8, s8, 7
    s_lshl_b32 s8, s8, 10
    s_add_u32 s8, s8, 131072
    v_add_u32 v254, s8, v5
    s_xor_b32 s8, s7, 3
    s_add_u32 s8, s8, s6
    s_and_b32 s8, s8, 7
    s_lshl_b32 s8, s8, 10
    s_add_u32 s8, s8, 131072
    v_add_u32 v255, s8, v5
    s_xor_b32 s8, s7, 7
    s_add_u32 s8, s8, s6
    s_and_b32 s83, s8, 7
    s_lshr_b32 s7, s83, 2
    s_lshl_b32 s26, s7, 15
    s_and_b32 s8, s83, 3
    s_lshl_b32 s8, s8, 10
    s_add_u32 s26, s26, s8
    s_add_u32 s26, s26, s12
    s_lshl_b32 s8, s5, 12
    s_add_u32 s26, s26, s8
    s_add_u32 s26, s26, 1048576
    s_lshl_b32 s27, 1, s83
    s_lshr_b32 s8, s2, 3
    s_and_b32 s7, s8, 7
    s_lshl_b32 s7, s7, 10
    s_lshr_b32 s8, s8, 1
    s_and_b32 s8, s8, 4
    s_xor_b32 s8, s8, s3
    s_lshl_b32 s28, s8, 13
    s_add_u32 s28, s28, s7
    s_mov_b32 s71, 0
    s_cmp_eq_u32 s3, 0
    s_cselect_b32 s71, 4164, s71
    s_cmp_eq_u32 s3, 1
    s_cselect_b32 s71, 1088, s71
    s_cmp_eq_u32 s3, 3
    s_cselect_b32 s71, 2428, s71
    s_cmp_eq_u32 s3, 4
    s_cselect_b32 s71, 68, s71
    s_cmp_eq_u32 s3, 5
    s_cselect_b32 s71, 2304, s71
    s_cmp_eq_u32 s3, 6
    s_cselect_b32 s71, 272, s71
    s_lshl_b32 s7, s69, 14
    s_lshl_b32 s8, s81, 15
    s_add_u32 s7, s7, s8
    v_add_u32 v6, 0, v3
    v_xor_b32 v6, v6, v2
    v_lshlrev_b32 v6, 4, v6
    v_lshl_add_u32 v6, v2, 10, v6
    v_add_u32 v12, s7, v6
    v_add_u32 v6, 4, v3
    v_xor_b32 v6, v6, v2
    v_lshlrev_b32 v6, 4, v6
    v_lshl_add_u32 v6, v2, 10, v6
    v_add_u32 v13, s7, v6
    v_add_u32 v6, 8, v3
    v_xor_b32 v6, v6, v2
    v_lshlrev_b32 v6, 4, v6
    v_lshl_add_u32 v6, v2, 10, v6
    v_add_u32 v14, s7, v6
    v_add_u32 v6, 12, v3
    v_xor_b32 v6, v6, v2
    v_lshlrev_b32 v6, 4, v6
    v_lshl_add_u32 v6, v2, 10, v6
    v_add_u32 v15, s7, v6
    v_lshrrev_b32 v8, 2, v2
    v_and_b32 v9, 3, v2
    v_and_b32 v6, 1, v3
    v_lshlrev_b32 v6, 7, v6
    v_lshl_add_u32 v6, v3, 8, v6
    v_lshl_add_u32 v6, v8, 5, v6
    v_lshl_add_u32 v6, v9, 3, v6
    v_add_u32 v16, 131072, v6
    v_xor_b32 v17, 128, v16
    v_and_b32 v6, 1, v2
    v_lshlrev_b32 v6, 10, v6
    v_lshl_add_u32 v6, v3, 4, v6
    v_add_u32 v18, 159744, v6
    v_and_b32 v6, 1, v3
    v_lshrrev_b32 v7, 1, v8
    v_lshl_or_b32 v6, v6, 1, v7
    s_and_b32 s6, s3, 3
    v_xor_b32 v6, s6, v6
    v_lshlrev_b32 v6, 5, v6
    v_lshl_add_u32 v6, v9, 3, v6
    v_lshl_add_u32 v7, v3, 3, v8
    v_lshl_add_u32 v6, v7, 7, v6
    v_add_u32 v26, 65536, v6
    s_lshl_b32 s6, s69, 4
    v_add_u32 v30, s6, v2
    v_mov_b32 v27, v30
    v_lshrrev_b32 v6, 1, v3
    v_lshlrev_b32 v6, 9, v6
    v_and_b32 v7, 1, v3
    v_lshl_add_u32 v6, v7, 3, v6
    s_and_b32 s6, s3, 3
    s_lshl_b32 s7, s81, 2
    s_add_u32 s6, s6, s7
    s_lshl_b32 s6, s6, 10
    s_add_u32 s6, s6, 131072
    v_add_u32 v6, s6, v6
    v_lshl_add_u32 v28, v30, 4, v6
    v_xor_b32 v29, 256, v28
    v_lshlrev_b32 v30, 2, v30
    v_add_u32 v30, 162816, v30
    v_xor_b32 v31, 64, v30
    v_and_b32 v6, 31, v1
    v_lshrrev_b32 v7, 5, v1
    v_lshlrev_b32 v240, 5, v6
    v_lshl_add_u32 v240, v7, 4, v240
    v_lshlrev_b32 v242, 2, v6
    v_add_u32 v242, 162816, v242
    v_lshlrev_b32 v243, 7, v6
    v_mov_b32 v52, 1
    s_cmp_ge_u32 s3, 4
    s_cbranch_scc1 L_2hi
    s_cmp_eq_u32 s3, 0
    s_cbranch_scc0 L_2lo
    s_lshl_b32 s7, s70, 8
    s_add_u32 s7, s7, 131072
    buffer_store_dword v19, v4, s[60:63], s7 offen sc1
    v_lshlrev_b32 v6, 5, v27
    v_lshl_add_u32 v6, v3, 3, v6
    v_and_b32 v20, 1, v3
    v_lshlrev_b32 v20, 9, v20
    v_lshl_add_u32 v20, v2, 4, v20
    v_lshrrev_b32 v7, 1, v3
    v_lshl_add_u32 v20, v7, 3, v20
    s_lshl_b32 s7, s69, 8
    s_add_u32 s7, s7, 65536
    v_add_u32 v20, s7, v20
    s_lshl_b32 s6, s82, 10
    s_cmp_ge_u32 s5, 4
    s_cselect_b64 s[22:23], -1, 0
    v_cndmask_b32 v6, v6, v20, s[22:23]
    s_waitcnt vmcnt(1)
    s_mov_b64 exec, 1
    ds_add_u32 v53, v52 offset:4
    s_mov_b64 exec, -1
L_p1w_1:
    ds_read_b32 v7, v53 offset:4
    s_waitcnt lgkmcnt(0)
    v_cmp_ne_u32 vcc, 4, v7
    s_nop 1
    s_cbranch_vccnz L_p1w_1
    ds_read_b128 v[64:67], v12 offset:0
    ds_read_b64_tr_b16 v[32:33], v16 offset:0
    ds_read_b64_tr_b16 v[34:35], v17 offset:0
    ds_read_b128 v[68:71], v13 offset:0
    ds_read_b64_tr_b16 v[36:37], v16 offset:1024
    ds_read_b64_tr_b16 v[38:39], v17 offset:1024
    ds_read_b128 v[72:75], v14 offset:0
    ds_read_b64_tr_b16 v[40:41], v16 offset:2048
    ds_read_b64_tr_b16 v[42:43], v17 offset:2048
    ds_read_b128 v[76:79], v15 offset:0
    ds_read_b64_tr_b16 v[44:45], v16 offset:3072
    ds_read_b64_tr_b16 v[46:47], v17 offset:3072
    ds_read_b128 v[80:83], v12 offset:256
    ds_read_b64_tr_b16 v[48:49], v16 offset:4096
    ds_read_b64_tr_b16 v[50:51], v17 offset:4096
    s_waitcnt lgkmcnt(12)
    v_mfma_f32_16x16x32_bf16 v[248:251], v[32:35], v[64:67], 0
    v_mfma_f32_16x16x32_bf16 v[244:247], v[64:67], v[32:35], 0
    ds_read_b128 v[84:87], v13 offset:256
    ds_read_b64_tr_b16 v[32:33], v16 offset:5120
    ds_read_b64_tr_b16 v[34:35], v17 offset:5120
    s_waitcnt lgkmcnt(12)
    v_mfma_f32_16x16x32_bf16 v[248:251], v[36:39], v[68:71], v[248:251]
    v_mfma_f32_16x16x32_bf16 v[244:247], v[68:71], v[36:39], v[244:247]
    ds_read_b128 v[88:91], v14 offset:256
    ds_read_b64_tr_b16 v[36:37], v16 offset:6144
    ds_read_b64_tr_b16 v[38:39], v17 offset:6144
    s_waitcnt lgkmcnt(12)
    v_mfma_f32_16x16x32_bf16 v[248:251], v[40:43], v[72:75], v[248:251]
    v_mfma_f32_16x16x32_bf16 v[244:247], v[72:75], v[40:43], v[244:247]
    ds_read_b128 v[92:95], v15 offset:256
    ds_read_b64_tr_b16 v[40:41], v16 offset:7168
    ds_read_b64_tr_b16 v[42:43], v17 offset:7168
    s_waitcnt lgkmcnt(12)
    v_mfma_f32_16x16x32_bf16 v[248:251], v[44:47], v[76:79], v[248:251]
    v_mfma_f32_16x16x32_bf16 v[244:247], v[76:79], v[44:47], v[244:247]
    ds_read_b128 v[96:99], v12 offset:512
    ds_read_b64_tr_b16 v[44:45], v16 offset:8192
    ds_read_b64_tr_b16 v[46:47], v17 offset:8192
    s_waitcnt lgkmcnt(12)
    v_mfma_f32_16x16x32_bf16 v[248:251], v[48:51], v[80:83], v[248:251]
    v_mfma_f32_16x16x32_bf16 v[244:247], v[80:83], v[48:51], v[244:247]
    ds_read_b128 v[100:103], v13 offset:512
    ds_read_b64_tr_b16 v[48:49], v16 offset:9216
    ds_read_b64_tr_b16 v[50:51], v17 offset:9216
    s_waitcnt lgkmcnt(12)
    v_mfma_f32_16x16x32_bf16 v[248:251], v[32:35], v[84:87], v[248:251]
    v_mfma_f32_16x16x32_bf16 v[244:247], v[84:87], v[32:35], v[244:247]
    ds_read_b128 v[104:107], v14 offset:512
    ds_read_b64_tr_b16 v[32:33], v16 offset:10240
    ds_read_b64_tr_b16 v[34:35], v17 offset:10240
    s_waitcnt lgkmcnt(12)
    v_mfma_f32_16x16x32_bf16 v[248:251], v[36:39], v[88:91], v[248:251]
    v_mfma_f32_16x16x32_bf16 v[244:247], v[88:91], v[36:39], v[244:247]
    ds_read_b128 v[108:111], v15 offset:512
    ds_read_b64_tr_b16 v[36:37], v16 offset:11264
    ds_read_b64_tr_b16 v[38:39], v17 offset:11264
    s_waitcnt lgkmcnt(12)
    v_mfma_f32_16x16x32_bf16 v[248:251], v[40:43], v[92:95], v[248:251]
    v_mfma_f32_16x16x32_bf16 v[244:247], v[92:95], v[40:43], v[244:247]
    ds_read_b128 v[112:115], v12 offset:768
    ds_read_b64_tr_b16 v[40:41], v16 offset:12288
    ds_read_b64_tr_b16 v[42:43], v17 offset:12288
    s_waitcnt lgkmcnt(12)
    v_mfma_f32_16x16x32_bf16 v[248:251], v[44:47], v[96:99], v[248:251]
    v_mfma_f32_16x16x32_bf16 v[244:247], v[96:99], v[44:47], v[244:247]
    ds_read_b128 v[116:119], v13 offset:768
    ds_read_b64_tr_b16 v[44:45], v16 offset:13312
    ds_read_b64_tr_b16 v[46:47], v17 offset:13312
    s_waitcnt lgkmcnt(12)
    v_mfma_f32_16x16x32_bf16 v[248:251], v[48:51], v[100:103], v[248:251]
    v_mfma_f32_16x16x32_bf16 v[244:247], v[100:103], v[48:51], v[244:247]
    ds_read_b128 v[120:123], v14 offset:768
    ds_read_b64_tr_b16 v[48:49], v16 offset:14336
    ds_read_b64_tr_b16 v[50:51], v17 offset:14336
    s_waitcnt lgkmcnt(12)
    v_mfma_f32_16x16x32_bf16 v[248:251], v[32:35], v[104:107], v[248:251]
    v_mfma_f32_16x16x32_bf16 v[244:247], v[104:107], v[32:35], v[244:247]
    ds_read_b128 v[124:127], v15 offset:768
    ds_read_b64_tr_b16 v[32:33], v16 offset:15360
    ds_read_b64_tr_b16 v[34:35], v17 offset:15360
    s_waitcnt lgkmcnt(12)
    v_mfma_f32_16x16x32_bf16 v[248:251], v[36:39], v[108:111], v[248:251]
    v_mfma_f32_16x16x32_bf16 v[244:247], v[108:111], v[36:39], v[244:247]
    s_waitcnt lgkmcnt(9)
    v_mfma_f32_16x16x32_bf16 v[248:251], v[40:43], v[112:115], v[248:251]
    v_mfma_f32_16x16x32_bf16 v[244:247], v[112:115], v[40:43], v[244:247]
    s_waitcnt lgkmcnt(6)
    v_mfma_f32_16x16x32_bf16 v[248:251], v[44:47], v[116:119], v[248:251]
    v_mfma_f32_16x16x32_bf16 v[244:247], v[116:119], v[44:47], v[244:247]
    s_waitcnt lgkmcnt(3)
    v_mfma_f32_16x16x32_bf16 v[248:251], v[48:51], v[120:123], v[248:251]
    v_mfma_f32_16x16x32_bf16 v[244:247], v[120:123], v[48:51], v[244:247]
    s_waitcnt lgkmcnt(0)
    v_mfma_f32_16x16x32_bf16 v[248:251], v[32:35], v[124:127], v[248:251]
    v_mfma_f32_16x16x32_bf16 v[244:247], v[124:127], v[32:35], v[244:247]
    v_xor_b32 v12, 0x4000, v12
    v_xor_b32 v13, 0x4000, v13
    v_xor_b32 v14, 0x4000, v14
    v_xor_b32 v15, 0x4000, v15
    s_nop 3
    v_cndmask_b32 v244, v248, v244, s[22:23]
    v_cndmask_b32 v245, v249, v245, s[22:23]
    v_cndmask_b32 v246, v250, v246, s[22:23]
    v_cndmask_b32 v247, v251, v247, s[22:23]
    v_cvt_pk_bf16_f32 v20, v244, v245
    v_cvt_pk_bf16_f32 v21, v246, v247
    buffer_store_dwordx2 v[20:21], v6, s[60:63], s6 offen sc1
    ds_read_b128 v[32:35], v18 offset:0
    ds_read_b128 v[36:39], v18 offset:64
    ds_read_b128 v[40:43], v18 offset:128
    ds_read_b128 v[44:47], v18 offset:192
    ds_read_b128 v[48:51], v18 offset:256
    s_waitcnt lgkmcnt(4)
    v_mfma_f32_16x16x32_bf16 v[244:247], v[32:35], v[64:67], 0
    ds_read_b128 v[32:35], v18 offset:320
    s_waitcnt lgkmcnt(4)
    v_mfma_f32_16x16x32_bf16 v[244:247], v[36:39], v[68:71], v[244:247]
    ds_read_b128 v[36:39], v18 offset:384
    s_waitcnt lgkmcnt(4)
    v_mfma_f32_16x16x32_bf16 v[244:247], v[40:43], v[72:75], v[244:247]
    ds_read_b128 v[40:43], v18 offset:448
    s_waitcnt lgkmcnt(4)
    v_mfma_f32_16x16x32_bf16 v[244:247], v[44:47], v[76:79], v[244:247]
    ds_read_b128 v[44:47], v18 offset:512
    s_waitcnt lgkmcnt(4)
    v_mfma_f32_16x16x32_bf16 v[244:247], v[48:51], v[80:83], v[244:247]
    ds_read_b128 v[48:51], v18 offset:576
    s_waitcnt lgkmcnt(4)
    v_mfma_f32_16x16x32_bf16 v[244:247], v[32:35], v[84:87], v[244:247]
    ds_read_b128 v[32:35], v18 offset:640
    s_waitcnt lgkmcnt(4)
    v_mfma_f32_16x16x32_bf16 v[244:247], v[36:39], v[88:91], v[244:247]
    ds_read_b128 v[36:39], v18 offset:704
    s_waitcnt lgkmcnt(4)
    v_mfma_f32_16x16x32_bf16 v[244:247], v[40:43], v[92:95], v[244:247]
    ds_read_b128 v[40:43], v18 offset:768
    s_waitcnt lgkmcnt(4)
    v_mfma_f32_16x16x32_bf16 v[244:247], v[44:47], v[96:99], v[244:247]
    ds_read_b128 v[44:47], v18 offset:832
    s_waitcnt lgkmcnt(4)
    v_mfma_f32_16x16x32_bf16 v[244:247], v[48:51], v[100:103], v[244:247]
    ds_read_b128 v[48:51], v18 offset:896
    s_waitcnt lgkmcnt(4)
    v_mfma_f32_16x16x32_bf16 v[244:247], v[32:35], v[104:107], v[244:247]
    ds_read_b128 v[32:35], v18 offset:960
    s_waitcnt lgkmcnt(4)
    v_mfma_f32_16x16x32_bf16 v[244:247], v[36:39], v[108:111], v[244:247]
    s_waitcnt lgkmcnt(3)
    v_mfma_f32_16x16x32_bf16 v[244:247], v[40:43], v[112:115], v[244:247]
    s_waitcnt lgkmcnt(2)
    v_mfma_f32_16x16x32_bf16 v[244:247], v[44:47], v[116:119], v[244:247]
    s_waitcnt lgkmcnt(1)
    v_mfma_f32_16x16x32_bf16 v[244:247], v[48:51], v[120:123], v[244:247]
    s_waitcnt lgkmcnt(0)
    v_mfma_f32_16x16x32_bf16 v[244:247], v[32:35], v[124:127], v[244:247]
    v_mul_f32 v23, v248, v248
    v_fmac_f32 v23, v249, v249
    v_fmac_f32 v23, v250, v250
    v_fmac_f32 v23, v251, v251
    v_mov_b32 v22, v23
    s_nop 1
    v_permlane32_swap_b32 v23, v22
    v_add_f32 v23, v23, v22
    v_mov_b32 v22, v23
    s_nop 1
    v_permlane16_swap_b32 v23, v22
    v_add_f32 v23, v23, v22
    s_nop 1
    v_max_u32_dpp v23, v23, v23 row_ror:8 row_mask:0xf bank_mask:0xf
    s_nop 1
    v_max_u32_dpp v23, v23, v23 row_ror:4 row_mask:0xf bank_mask:0xf
    s_nop 1
    v_max_u32_dpp v23, v23, v23 row_ror:2 row_mask:0xf bank_mask:0xf
    s_nop 1
    v_max_u32_dpp v23, v23, v23 row_ror:1 row_mask:0xf bank_mask:0xf
    v_cndmask_b32 v23, v23, v19, s[22:23]
    s_lshl_b32 s6, s82, 5
    v_add_u32 v6, s6, v27
    s_mul_i32 s68, s68, 0x9e3779b9
    s_add_u32 s68, s68, 0x7f4a7c15
    v_mov_b32 v22, s68
    v_mov_b32 v24, s68
    ds_write_b32 v53, v22
    s_lshl_b32 s7, s70, 7
    s_add_u32 s7, s7, 262144
    v_cvt_pk_bf16_f32 v244, v244, v244
    v_and_b32 v244, 0xffff0000, v244
    v_ashrrev_i32 v25, 31, v244
    v_or_b32 v25, 0x80000000, v25
    v_xor_b32 v25, v25, v244
    v_and_b32 v25, 0xffff0000, v25
    v_or_b32 v25, v25, v6
    s_nop 1
    v_max_u32_dpp v25, v25, v25 row_ror:8 row_mask:0xf bank_mask:0xf
    s_nop 1
    v_max_u32_dpp v25, v25, v25 row_ror:4 row_mask:0xf bank_mask:0xf
    s_nop 1
    v_max_u32_dpp v25, v25, v25 row_ror:2 row_mask:0xf bank_mask:0xf
    s_nop 1
    v_max_u32_dpp v25, v25, v25 row_ror:1 row_mask:0xf bank_mask:0xf
    s_mov_b64 exec, 1
    s_waitcnt vmcnt(0)
    buffer_store_dwordx4 v[22:25], v19, s[60:63], s7 offen sc1
    s_mov_b64 exec, -1
    v_cvt_pk_bf16_f32 v245, v245, v245
    v_and_b32 v245, 0xffff0000, v245
    v_mul_f32 v245, 0xbfb8aa3b, v245
    v_exp_f32 v245, v245
    s_nop 0
    v_add_f32 v245, 1.0, v245
    v_rcp_f32 v245, v245
    s_nop 0
    v_cvt_pk_bf16_f32 v245, v245, v245
    v_and_b32 v245, 0xffff0000, v245
    v_lshlrev_b32 v6, 2, v6
    s_mov_b32 s7, 393216
    s_mov_b64 exec, 0xffff
    buffer_store_dword v245, v6, s[60:63], s7 offen sc1
    s_mov_b64 exec, -1
    v_lshlrev_b32 v10, 2, v3
    v_xor_b32 v10, v10, v2
    v_lshlrev_b32 v10, 4, v10
    v_lshl_add_u32 v10, v3, 10, v10
    s_lshr_b32 s6, s5, 1
    s_lshl_b32 s6, s6, 8
    v_add_u32 v10, s6, v10
    s_waitcnt lgkmcnt(0)
    s_branch L_B1lo
L_2hi:
    s_add_u32 m0, s10, 0
    s_xor_b32 s6, s78, 0
    buffer_load_dwordx4 v10, s[48:51], s6 offen lds
    s_add_u32 m0, s10, 4096
    s_xor_b32 s6, s78, 32768
    buffer_load_dwordx4 v10, s[48:51], s6 offen lds
    s_add_u32 m0, s10, 8192
    s_xor_b32 s6, s78, 65536
    buffer_load_dwordx4 v10, s[48:51], s6 offen lds
    s_add_u32 m0, s10, 12288
    s_xor_b32 s6, s78, 98304
    buffer_load_dwordx4 v10, s[48:51], s6 offen lds
    s_add_u32 m0, s10, 16384
    s_xor_b32 s6, s78, 131072
    buffer_load_dwordx4 v10, s[48:51], s6 offen lds
    s_add_u32 m0, s10, 20480
    s_xor_b32 s6, s78, 163840
    buffer_load_dwordx4 v10, s[48:51], s6 offen lds
    s_add_u32 m0, s10, 24576
    s_xor_b32 s6, s78, 196608
    buffer_load_dwordx4 v10, s[48:51], s6 offen lds
    s_add_u32 m0, s10, 28672
    s_xor_b32 s6, s78, 229376
    buffer_load_dwordx4 v10, s[48:51], s6 offen lds
    s_add_u32 m0, s10, 32768
    s_xor_b32 s6, s78, 262144
    buffer_load_dwordx4 v10, s[48:51], s6 offen lds
    s_add_u32 m0, s10, 36864
    s_xor_b32 s6, s78, 294912
    buffer_load_dwordx4 v10, s[48:51], s6 offen lds
    s_add_u32 m0, s10, 40960
    s_xor_b32 s6, s78, 327680
    buffer_load_dwordx4 v10, s[48:51], s6 offen lds
    s_add_u32 m0, s10, 45056
    s_xor_b32 s6, s78, 360448
    buffer_load_dwordx4 v10, s[48:51], s6 offen lds
    s_add_u32 m0, s10, 49152
    s_xor_b32 s6, s78, 393216
    buffer_load_dwordx4 v10, s[48:51], s6 offen lds
    s_add_u32 m0, s10, 53248
    s_xor_b32 s6, s78, 425984
    buffer_load_dwordx4 v10, s[48:51], s6 offen lds
    s_add_u32 m0, s10, 57344
    s_xor_b32 s6, s78, 458752
    buffer_load_dwordx4 v10, s[48:51], s6 offen lds
    s_add_u32 m0, s10, 61440
    s_xor_b32 s6, s78, 491520
    buffer_load_dwordx4 v10, s[48:51], s6 offen lds
    v_mov_b32 v20, v12
    v_mov_b32 v21, v13
    v_mov_b32 v22, v14
    v_mov_b32 v23, v15
    v_xor_b32 v12, 0x4000, v12
    v_xor_b32 v13, 0x4000, v13
    v_xor_b32 v14, 0x4000, v14
    v_xor_b32 v15, 0x4000, v15
    v_lshlrev_b32 v10, 2, v3
    v_xor_b32 v10, v10, v2
    v_lshlrev_b32 v10, 4, v10
    v_lshl_add_u32 v10, v3, 10, v10
    s_lshr_b32 s6, s5, 1
    s_lshl_b32 s6, s6, 8
    v_add_u32 v10, s6, v10
    s_waitcnt vmcnt(8) lgkmcnt(0)
    s_branch L_qhi
L_2lo:
    s_add_u32 m0, s15, 0
    s_add_u32 s11, s12, m0
    v_xor_b32 v7, 0, v11
    buffer_load_dwordx4 v7, s[44:47], s11 offen lds
    v_xor_b32 v7, 16, v11
    buffer_load_dwordx4 v7, s[44:47], s11 offen offset:1024 lds
    v_xor_b32 v7, 32, v11
    buffer_load_dwordx4 v7, s[44:47], s11 offen offset:2048 lds
    v_xor_b32 v7, 48, v11
    buffer_load_dwordx4 v7, s[44:47], s11 offen offset:3072 lds
    s_waitcnt vmcnt(4)
    s_mov_b64 exec, 1
    ds_add_u32 v53, v52 offset:4
    s_mov_b64 exec, -1
    s_add_u32 m0, s15, 4096
    s_add_u32 s11, s12, m0
    v_xor_b32 v7, 64, v11
    buffer_load_dwordx4 v7, s[44:47], s11 offen lds
    v_xor_b32 v7, 80, v11
    buffer_load_dwordx4 v7, s[44:47], s11 offen offset:1024 lds
    v_xor_b32 v7, 96, v11
    buffer_load_dwordx4 v7, s[44:47], s11 offen offset:2048 lds
    v_xor_b32 v7, 112, v11
    buffer_load_dwordx4 v7, s[44:47], s11 offen offset:3072 lds
    s_add_u32 m0, s15, 8192
    s_add_u32 s11, s12, m0
    v_xor_b32 v7, 128, v11
    buffer_load_dwordx4 v7, s[44:47], s11 offen lds
    v_xor_b32 v7, 144, v11
    buffer_load_dwordx4 v7, s[44:47], s11 offen offset:1024 lds
    v_xor_b32 v7, 160, v11
    buffer_load_dwordx4 v7, s[44:47], s11 offen offset:2048 lds
    v_xor_b32 v7, 176, v11
    buffer_load_dwordx4 v7, s[44:47], s11 offen offset:3072 lds
    s_add_u32 m0, s15, 12288
    s_add_u32 s11, s12, m0
    v_xor_b32 v7, 192, v11
    buffer_load_dwordx4 v7, s[44:47], s11 offen lds
    v_xor_b32 v7, 208, v11
    buffer_load_dwordx4 v7, s[44:47], s11 offen offset:1024 lds
    v_xor_b32 v7, 224, v11
    buffer_load_dwordx4 v7, s[44:47], s11 offen offset:2048 lds
    v_xor_b32 v7, 240, v11
    buffer_load_dwordx4 v7, s[44:47], s11 offen offset:3072 lds
L_p1w_2:
    ds_read_b32 v7, v53 offset:4
    s_waitcnt lgkmcnt(0)
    v_cmp_ne_u32 vcc, 4, v7
    s_nop 1
    s_cbranch_vccnz L_p1w_2
    ds_read_b128 v[64:67], v12 offset:0
    ds_read_b128 v[68:71], v13 offset:0
    ds_read_b128 v[72:75], v14 offset:0
    ds_read_b128 v[76:79], v15 offset:0
    ds_read_b128 v[80:83], v12 offset:256
    ds_read_b128 v[84:87], v13 offset:256
    ds_read_b128 v[88:91], v14 offset:256
    ds_read_b128 v[92:95], v15 offset:256
    ds_read_b128 v[96:99], v12 offset:512
    ds_read_b128 v[100:103], v13 offset:512
    ds_read_b128 v[104:107], v14 offset:512
    ds_read_b128 v[108:111], v15 offset:512
    ds_read_b128 v[112:115], v12 offset:768
    ds_read_b128 v[116:119], v13 offset:768
    ds_read_b128 v[120:123], v14 offset:768
    ds_read_b128 v[124:127], v15 offset:768
    v_xor_b32 v12, 0x4000, v12
    v_xor_b32 v13, 0x4000, v13
    v_xor_b32 v14, 0x4000, v14
    v_xor_b32 v15, 0x4000, v15
    v_lshlrev_b32 v10, 2, v3
    v_xor_b32 v10, v10, v2
    v_lshlrev_b32 v10, 4, v10
    v_lshl_add_u32 v10, v3, 10, v10
    s_lshr_b32 s6, s5, 1
    s_lshl_b32 s6, s6, 8
    v_add_u32 v10, s6, v10
    s_movk_i32 s6, 3584
    v_mul_lo_u32 v11, v1, s6
    s_lshl_b32 s6, s76, 1
    v_add_u32 v11, s6, v11
    v_mul_u32_u24 v16, 1088, v8
    v_lshl_add_u32 v16, v3, 5, v16
    v_lshl_add_u32 v16, v9, 3, v16
    v_add_u32 v16, 98304, v16
    v_cmp_eq_u32 vcc, v8, v3
    v_mov_b32 v6, 161824
    v_mov_b32 v7, 162048
    v_cndmask_b32 v17, v6, v7, vcc
    v_lshl_add_u32 v0, v3, 2, v2
    v_lshl_add_u32 v0, v0, 1, v7
    v_lshrrev_b32 v6, 1, v9
    v_mul_u32_u24 v6, 8256, v6
    v_and_b32 v7, 1, v9
    v_lshl_add_u32 v6, v7, 3, v6
    v_lshl_add_u32 v7, v3, 3, v8
    v_lshl_add_u32 v8, v7, 4, v6
    v_add_u32 v8, 98304, v8
    v_lshlrev_b32 v9, 4, v3
    v_add_u32 v9, 98304, v9
    s_waitcnt vmcnt(0)
L_B1lo:
    s_barrier
    ds_read_b32 v52, v53
    ds_read_b128 v[128:131], v12 offset:0
    ds_read_b64_tr_b16 v[32:33], v26 offset:0
    ds_read_b64_tr_b16 v[34:35], v26 offset:512
    ds_read_b128 v[132:135], v13 offset:0
    ds_read_b64_tr_b16 v[36:37], v26 offset:4096
    ds_read_b64_tr_b16 v[38:39], v26 offset:4608
    ds_read_b128 v[136:139], v14 offset:0
    ds_read_b64_tr_b16 v[40:41], v26 offset:8192
    ds_read_b64_tr_b16 v[42:43], v26 offset:8704
    ds_read_b128 v[140:143], v15 offset:0
    ds_read_b64_tr_b16 v[44:45], v26 offset:12288
    ds_read_b64_tr_b16 v[46:47], v26 offset:12800
    s_lshr_b32 s9, s28, 13
    s_lshl_b32 s9, s9, 12
    s_add_u32 s9, s9, 262144
    ds_read_b128 v[144:147], v12 offset:256
    ds_read_b64_tr_b16 v[48:49], v26 offset:16384
    ds_read_b64_tr_b16 v[50:51], v26 offset:16896
    s_waitcnt lgkmcnt(12)
    v_mfma_f32_16x16x32_bf16 v[248:251], v[32:35], v[64:67], 0
    v_mfma_f32_16x16x32_bf16 v[244:247], v[32:35], v[128:131], 0
    ds_read_b128 v[148:151], v13 offset:256
    ds_read_b64_tr_b16 v[32:33], v26 offset:20480
    ds_read_b64_tr_b16 v[34:35], v26 offset:20992
    s_waitcnt lgkmcnt(12)
    v_mfma_f32_16x16x32_bf16 v[248:251], v[36:39], v[68:71], v[248:251]
    v_mfma_f32_16x16x32_bf16 v[244:247], v[36:39], v[132:135], v[244:247]
    ds_read_b128 v[152:155], v14 offset:256
    ds_read_b64_tr_b16 v[36:37], v26 offset:24576
    ds_read_b64_tr_b16 v[38:39], v26 offset:25088
    s_waitcnt lgkmcnt(12)
    v_mfma_f32_16x16x32_bf16 v[248:251], v[40:43], v[72:75], v[248:251]
    v_mfma_f32_16x16x32_bf16 v[244:247], v[40:43], v[136:139], v[244:247]
    ds_read_b128 v[156:159], v15 offset:256
    ds_read_b64_tr_b16 v[40:41], v26 offset:28672
    ds_read_b64_tr_b16 v[42:43], v26 offset:29184
    s_waitcnt lgkmcnt(12)
    v_mfma_f32_16x16x32_bf16 v[248:251], v[44:47], v[76:79], v[248:251]
    v_mfma_f32_16x16x32_bf16 v[244:247], v[44:47], v[140:143], v[244:247]
    s_barrier
    ds_read_b128 v[160:163], v12 offset:512
    ds_read_b64_tr_b16 v[44:45], v26 offset:32768
    ds_read_b64_tr_b16 v[46:47], v26 offset:33280
    s_waitcnt lgkmcnt(12)
    v_mfma_f32_16x16x32_bf16 v[248:251], v[48:51], v[80:83], v[248:251]
    v_mfma_f32_16x16x32_bf16 v[244:247], v[48:51], v[144:147], v[244:247]
    ds_read_b128 v[164:167], v13 offset:512
    ds_read_b64_tr_b16 v[48:49], v26 offset:36864
    ds_read_b64_tr_b16 v[50:51], v26 offset:37376
    s_waitcnt lgkmcnt(12)
    v_mfma_f32_16x16x32_bf16 v[248:251], v[32:35], v[84:87], v[248:251]
    v_mfma_f32_16x16x32_bf16 v[244:247], v[32:35], v[148:151], v[244:247]
    buffer_load_dwordx4 v[232:235], v243, s[60:63], s9 offen sc1
    ds_read_b128 v[168:171], v14 offset:512
    ds_read_b64_tr_b16 v[32:33], v26 offset:40960
    ds_read_b64_tr_b16 v[34:35], v26 offset:41472
    s_waitcnt lgkmcnt(12)
    v_mfma_f32_16x16x32_bf16 v[248:251], v[36:39], v[88:91], v[248:251]
    v_mfma_f32_16x16x32_bf16 v[244:247], v[36:39], v[152:155], v[244:247]
    ds_read_b128 v[172:175], v15 offset:512
    ds_read_b64_tr_b16 v[36:37], v26 offset:45056
    ds_read_b64_tr_b16 v[38:39], v26 offset:45568
    s_waitcnt lgkmcnt(12)
    v_mfma_f32_16x16x32_bf16 v[248:251], v[40:43], v[92:95], v[248:251]
    v_mfma_f32_16x16x32_bf16 v[244:247], v[40:43], v[156:159], v[244:247]
    ds_read_b128 v[176:179], v12 offset:768
    ds_read_b64_tr_b16 v[40:41], v26 offset:49152
    ds_read_b64_tr_b16 v[42:43], v26 offset:49664
    s_waitcnt lgkmcnt(12)
    v_mfma_f32_16x16x32_bf16 v[248:251], v[44:47], v[96:99], v[248:251]
    v_mfma_f32_16x16x32_bf16 v[244:247], v[44:47], v[160:163], v[244:247]
    ds_read_b128 v[180:183], v13 offset:768
    ds_read_b64_tr_b16 v[44:45], v26 offset:53248
    ds_read_b64_tr_b16 v[46:47], v26 offset:53760
    s_waitcnt lgkmcnt(12)
    v_mfma_f32_16x16x32_bf16 v[248:251], v[48:51], v[100:103], v[248:251]
    v_mfma_f32_16x16x32_bf16 v[244:247], v[48:51], v[164:167], v[244:247]
    ds_read_b128 v[184:187], v14 offset:768
    ds_read_b64_tr_b16 v[48:49], v26 offset:57344
    ds_read_b64_tr_b16 v[50:51], v26 offset:57856
    s_waitcnt lgkmcnt(12)
    v_mfma_f32_16x16x32_bf16 v[248:251], v[32:35], v[104:107], v[248:251]
    v_mfma_f32_16x16x32_bf16 v[244:247], v[32:35], v[168:171], v[244:247]
    buffer_load_dwordx4 v[128:131], v243, s[60:63], s9 offen sc1
    ds_read_b128 v[188:191], v15 offset:768
    ds_read_b64_tr_b16 v[32:33], v26 offset:61440
    ds_read_b64_tr_b16 v[34:35], v26 offset:61952
    s_waitcnt lgkmcnt(12)
    v_mfma_f32_16x16x32_bf16 v[248:251], v[36:39], v[108:111], v[248:251]
    v_mfma_f32_16x16x32_bf16 v[244:247], v[36:39], v[172:175], v[244:247]
    s_waitcnt lgkmcnt(9)
    v_mfma_f32_16x16x32_bf16 v[248:251], v[40:43], v[112:115], v[248:251]
    v_mfma_f32_16x16x32_bf16 v[244:247], v[40:43], v[176:179], v[244:247]
    s_waitcnt lgkmcnt(6)
    v_mfma_f32_16x16x32_bf16 v[248:251], v[44:47], v[116:119], v[248:251]
    v_mfma_f32_16x16x32_bf16 v[244:247], v[44:47], v[180:183], v[244:247]
    s_waitcnt lgkmcnt(3)
    v_mfma_f32_16x16x32_bf16 v[248:251], v[48:51], v[120:123], v[248:251]
    v_mfma_f32_16x16x32_bf16 v[244:247], v[48:51], v[184:187], v[244:247]
    s_waitcnt lgkmcnt(0)
    v_mfma_f32_16x16x32_bf16 v[248:251], v[32:35], v[124:127], v[248:251]
    v_mfma_f32_16x16x32_bf16 v[244:247], v[32:35], v[188:191], v[244:247]
    s_branch L_qend
L_qhi:
    s_barrier
    ds_read_b32 v52, v53
    ds_read_b128 v[64:67], v20 offset:0
    ds_read_b128 v[128:131], v12 offset:0
    ds_read_b64_tr_b16 v[32:33], v26 offset:0
    ds_read_b64_tr_b16 v[34:35], v26 offset:512
    ds_read_b128 v[68:71], v21 offset:0
    ds_read_b128 v[132:135], v13 offset:0
    ds_read_b64_tr_b16 v[36:37], v26 offset:4096
    ds_read_b64_tr_b16 v[38:39], v26 offset:4608
    ds_read_b128 v[72:75], v22 offset:0
    ds_read_b128 v[136:139], v14 offset:0
    ds_read_b64_tr_b16 v[40:41], v26 offset:8192
    ds_read_b64_tr_b16 v[42:43], v26 offset:8704
    s_lshr_b32 s9, s28, 13
    s_lshl_b32 s9, s9, 12
    s_add_u32 s9, s9, 262144
    ds_read_b128 v[76:79], v23 offset:0
    ds_read_b128 v[140:143], v15 offset:0
    ds_read_b64_tr_b16 v[44:45], v26 offset:12288
    ds_read_b64_tr_b16 v[46:47], v26 offset:12800
    s_waitcnt lgkmcnt(12)
    v_mfma_f32_16x16x32_bf16 v[248:251], v[32:35], v[64:67], 0
    v_mfma_f32_16x16x32_bf16 v[244:247], v[32:35], v[128:131], 0
    ds_read_b128 v[80:83], v20 offset:256
    ds_read_b128 v[144:147], v12 offset:256
    ds_read_b64_tr_b16 v[48:49], v26 offset:16384
    ds_read_b64_tr_b16 v[50:51], v26 offset:16896
    s_waitcnt lgkmcnt(12)
    v_mfma_f32_16x16x32_bf16 v[248:251], v[36:39], v[68:71], v[248:251]
    v_mfma_f32_16x16x32_bf16 v[244:247], v[36:39], v[132:135], v[244:247]
    ds_read_b128 v[84:87], v21 offset:256
    ds_read_b128 v[148:151], v13 offset:256
    ds_read_b64_tr_b16 v[32:33], v26 offset:20480
    ds_read_b64_tr_b16 v[34:35], v26 offset:20992
    s_waitcnt lgkmcnt(12)
    v_mfma_f32_16x16x32_bf16 v[248:251], v[40:43], v[72:75], v[248:251]
    v_mfma_f32_16x16x32_bf16 v[244:247], v[40:43], v[136:139], v[244:247]
    ds_read_b128 v[88:91], v22 offset:256
    ds_read_b128 v[152:155], v14 offset:256
    ds_read_b64_tr_b16 v[36:37], v26 offset:24576
    ds_read_b64_tr_b16 v[38:39], v26 offset:25088
    s_waitcnt lgkmcnt(12)
    v_mfma_f32_16x16x32_bf16 v[248:251], v[44:47], v[76:79], v[248:251]
    v_mfma_f32_16x16x32_bf16 v[244:247], v[44:47], v[140:143], v[244:247]
    ds_read_b128 v[92:95], v23 offset:256
    ds_read_b128 v[156:159], v15 offset:256
    ds_read_b64_tr_b16 v[40:41], v26 offset:28672
    ds_read_b64_tr_b16 v[42:43], v26 offset:29184
    s_waitcnt lgkmcnt(12)
    v_mfma_f32_16x16x32_bf16 v[248:251], v[48:51], v[80:83], v[248:251]
    v_mfma_f32_16x16x32_bf16 v[244:247], v[48:51], v[144:147], v[244:247]
    s_waitcnt vmcnt(0)
    s_barrier
    ds_read_b128 v[96:99], v20 offset:512
    ds_read_b128 v[160:163], v12 offset:512
    ds_read_b64_tr_b16 v[44:45], v26 offset:32768
    ds_read_b64_tr_b16 v[46:47], v26 offset:33280
    s_waitcnt lgkmcnt(12)
    v_mfma_f32_16x16x32_bf16 v[248:251], v[32:35], v[84:87], v[248:251]
    v_mfma_f32_16x16x32_bf16 v[244:247], v[32:35], v[148:151], v[244:247]
    buffer_load_dwordx4 v[232:235], v243, s[60:63], s9 offen sc1
    ds_read_b128 v[100:103], v21 offset:512
    ds_read_b128 v[164:167], v13 offset:512
    ds_read_b64_tr_b16 v[48:49], v26 offset:36864
    ds_read_b64_tr_b16 v[50:51], v26 offset:37376
    s_waitcnt lgkmcnt(12)
    v_mfma_f32_16x16x32_bf16 v[248:251], v[36:39], v[88:91], v[248:251]
    v_mfma_f32_16x16x32_bf16 v[244:247], v[36:39], v[152:155], v[244:247]
    ds_read_b128 v[104:107], v22 offset:512
    ds_read_b128 v[168:171], v14 offset:512
    ds_read_b64_tr_b16 v[32:33], v26 offset:40960
    ds_read_b64_tr_b16 v[34:35], v26 offset:41472
    s_waitcnt lgkmcnt(12)
    v_mfma_f32_16x16x32_bf16 v[248:251], v[40:43], v[92:95], v[248:251]
    v_mfma_f32_16x16x32_bf16 v[244:247], v[40:43], v[156:159], v[244:247]
    ds_read_b128 v[108:111], v23 offset:512
    ds_read_b128 v[172:175], v15 offset:512
    ds_read_b64_tr_b16 v[36:37], v26 offset:45056
    ds_read_b64_tr_b16 v[38:39], v26 offset:45568
    s_waitcnt lgkmcnt(12)
    v_mfma_f32_16x16x32_bf16 v[248:251], v[44:47], v[96:99], v[248:251]
    v_mfma_f32_16x16x32_bf16 v[244:247], v[44:47], v[160:163], v[244:247]
    ds_read_b128 v[112:115], v20 offset:768
    ds_read_b128 v[176:179], v12 offset:768
    ds_read_b64_tr_b16 v[40:41], v26 offset:49152
    ds_read_b64_tr_b16 v[42:43], v26 offset:49664
    s_waitcnt lgkmcnt(12)
    v_mfma_f32_16x16x32_bf16 v[248:251], v[48:51], v[100:103], v[248:251]
    v_mfma_f32_16x16x32_bf16 v[244:247], v[48:51], v[164:167], v[244:247]
    ds_read_b128 v[116:119], v21 offset:768
    ds_read_b128 v[180:183], v13 offset:768
    ds_read_b64_tr_b16 v[44:45], v26 offset:53248
    ds_read_b64_tr_b16 v[46:47], v26 offset:53760
    s_waitcnt lgkmcnt(12)
    v_mfma_f32_16x16x32_bf16 v[248:251], v[32:35], v[104:107], v[248:251]
    v_mfma_f32_16x16x32_bf16 v[244:247], v[32:35], v[168:171], v[244:247]
    buffer_load_dwordx4 v[128:131], v243, s[60:63], s9 offen sc1
    ds_read_b128 v[120:123], v22 offset:768
    ds_read_b128 v[184:187], v14 offset:768
    ds_read_b64_tr_b16 v[48:49], v26 offset:57344
    ds_read_b64_tr_b16 v[50:51], v26 offset:57856
    s_waitcnt lgkmcnt(12)
    v_mfma_f32_16x16x32_bf16 v[248:251], v[36:39], v[108:111], v[248:251]
    v_mfma_f32_16x16x32_bf16 v[244:247], v[36:39], v[172:175], v[244:247]
    ds_read_b128 v[124:127], v23 offset:768
    ds_read_b128 v[188:191], v15 offset:768
    ds_read_b64_tr_b16 v[32:33], v26 offset:61440
    ds_read_b64_tr_b16 v[34:35], v26 offset:61952
    s_waitcnt lgkmcnt(12)
    v_mfma_f32_16x16x32_bf16 v[248:251], v[40:43], v[112:115], v[248:251]
    v_mfma_f32_16x16x32_bf16 v[244:247], v[40:43], v[176:179], v[244:247]
    s_waitcnt lgkmcnt(8)
    v_mfma_f32_16x16x32_bf16 v[248:251], v[44:47], v[116:119], v[248:251]
    v_mfma_f32_16x16x32_bf16 v[244:247], v[44:47], v[180:183], v[244:247]
    s_waitcnt lgkmcnt(4)
    v_mfma_f32_16x16x32_bf16 v[248:251], v[48:51], v[120:123], v[248:251]
    v_mfma_f32_16x16x32_bf16 v[244:247], v[48:51], v[184:187], v[244:247]
    s_waitcnt lgkmcnt(0)
    v_mfma_f32_16x16x32_bf16 v[248:251], v[32:35], v[124:127], v[248:251]
    v_mfma_f32_16x16x32_bf16 v[244:247], v[32:35], v[188:191], v[244:247]
L_qend:
    v_mov_b32 v26, v240
    v_add_u32 v27, 65536, v5
    s_mov_b32 s79, 0
    v_readfirstlane_b32 s68, v52
    s_waitcnt vmcnt(1)
    s_nop 0
    v_xor_b32 v6, s68, v232
    v_xor_b32 v7, s68, v234
    v_or_b32 v6, v6, v7
    v_cmp_ne_u32 vcc, 0, v6
    s_nop 1
    s_cbranch_vccz L_pollok
L_poll:
    s_waitcnt vmcnt(0)
    v_xor_b32 v6, s68, v128
    v_xor_b32 v7, s68, v130
    v_or_b32 v6, v6, v7
    v_cmp_ne_u32 vcc, 0, v6
    s_add_u32 s79, s79, 1
    s_cmp_gt_u32 s79, 262144
    s_cbranch_scc1 L_pollout
    s_cbranch_vccz L_pollout
    s_sleep 2
    buffer_load_dwordx4 v[128:131], v243, s[60:63], s9 offen sc1
    s_branch L_poll
L_pollout:
    v_mov_b32 v233, v129
    v_mov_b32 v235, v131
L_pollok:
    s_cmp_ge_u32 s3, 4
    s_cbranch_scc1 L_kvl1
    s_xor_b32 s7, s28, 0
    buffer_load_dwordx4 v[64:67], v26, s[60:63], s7 offen sc1
    buffer_load_dwordx4 v[96:99], v27, s[60:63], s7 offen sc1
    s_xor_b32 s7, s28, 1024
    buffer_load_dwordx4 v[68:71], v26, s[60:63], s7 offen sc1
    buffer_load_dwordx4 v[100:103], v27, s[60:63], s7 offen sc1
L_kvl1:
    s_mov_b32 s8, 0x3eb8aa3b
    v_mul_f32 v248, s8, v248
    v_mul_f32 v249, s8, v249
    v_mul_f32 v250, s8, v250
    v_mul_f32 v251, s8, v251
    v_cvt_pk_bf16_f32 v20, v248, v249
    v_cvt_pk_bf16_f32 v21, v250, v251
    ds_write_b64 v28, v[20:21]
    v_mul_f32 v24, v248, v248
    v_fmac_f32 v24, v249, v249
    v_fmac_f32 v24, v250, v250
    v_fmac_f32 v24, v251, v251
    v_mul_f32 v244, s8, v244
    v_mul_f32 v245, s8, v245
    v_mul_f32 v246, s8, v246
    v_mul_f32 v247, s8, v247
    v_cvt_pk_bf16_f32 v22, v244, v245
    v_cvt_pk_bf16_f32 v23, v246, v247
    ds_write_b64 v29, v[22:23]
    v_mul_f32 v25, v244, v244
    v_fmac_f32 v25, v245, v245
    v_fmac_f32 v25, v246, v246
    v_fmac_f32 v25, v247, v247
    v_mov_b32 v6, v24
    v_mov_b32 v7, v25
    v_max_u32_dpp v233, v233, v233 row_ror:8 row_mask:0xf bank_mask:0xf
    v_max_u32_dpp v235, v235, v235 row_ror:8 row_mask:0xf bank_mask:0xf
    v_permlane32_swap_b32 v24, v6
    v_permlane32_swap_b32 v25, v7
    v_max_u32_dpp v233, v233, v233 row_ror:4 row_mask:0xf bank_mask:0xf
    v_max_u32_dpp v235, v235, v235 row_ror:4 row_mask:0xf bank_mask:0xf
    v_add_f32 v24, v24, v6
    v_add_f32 v25, v25, v7
    v_max_u32_dpp v233, v233, v233 row_ror:2 row_mask:0xf bank_mask:0xf
    v_max_u32_dpp v235, v235, v235 row_ror:2 row_mask:0xf bank_mask:0xf
    v_mov_b32 v6, v24
    v_mov_b32 v7, v25
    v_max_u32_dpp v233, v233, v233 row_ror:1 row_mask:0xf bank_mask:0xf
    v_max_u32_dpp v235, v235, v235 row_ror:1 row_mask:0xf bank_mask:0xf
    v_permlane16_swap_b32 v24, v6
    v_permlane16_swap_b32 v25, v7
    v_mov_b32 v18, 161792
    v_add_f32 v24, v24, v6
    v_add_f32 v25, v25, v7
    s_mov_b64 exec, 0xffff
    ds_max_u32 v30, v24
    ds_max_u32 v31, v25
    s_mov_b64 exec, 0x10001
    ds_max_u32 v18, v233 offset:8
    ds_max_u32 v18, v235 offset:12
    s_mov_b64 exec, -1
    s_cmp_ge_u32 s3, 4
    s_cbranch_scc1 L_kvl1b
    s_xor_b32 s7, s28, 2048
    buffer_load_dwordx4 v[72:75], v26, s[60:63], s7 offen sc1
    buffer_load_dwordx4 v[104:107], v27, s[60:63], s7 offen sc1
    s_xor_b32 s7, s28, 3072
    buffer_load_dwordx4 v[76:79], v26, s[60:63], s7 offen sc1
    buffer_load_dwordx4 v[108:111], v27, s[60:63], s7 offen sc1
    s_xor_b32 s7, s28, 4096
    buffer_load_dwordx4 v[80:83], v26, s[60:63], s7 offen sc1
    buffer_load_dwordx4 v[112:115], v27, s[60:63], s7 offen sc1
L_kvl1b:
    s_waitcnt lgkmcnt(0)
    s_barrier
    ds_read_b64 v[6:7], v18 offset:8
    ds_read_b32 v19, v242
    ds_read_b128 v[248:251], v252
    s_waitcnt lgkmcnt(1)
    v_mul_f32 v19, v19, v6
    v_sqrt_f32 v19, v19
    v_readfirstlane_b32 s15, v7
    v_mul_f32 v224, 0xbf828f5c, v19
    v_mov_b32 v225, v224
    v_mov_b32 v226, v224
    v_mov_b32 v227, v224
    v_mov_b32 v228, v224
    v_mov_b32 v229, v224
    v_mov_b32 v230, v224
    v_mov_b32 v231, v224
    v_mov_b32 v232, v224
    v_mov_b32 v233, v224
    v_mov_b32 v234, v224
    v_mov_b32 v235, v224
    v_mov_b32 v236, v224
    v_mov_b32 v237, v224
    v_mov_b32 v238, v224
    v_mov_b32 v239, v224
    s_cmp_ge_u32 s3, 4
    s_cbranch_scc0 L_kvl2
    s_xor_b32 s7, s28, 0
    buffer_load_dwordx4 v[64:67], v26, s[60:63], s7 offen sc1
    buffer_load_dwordx4 v[96:99], v27, s[60:63], s7 offen sc1
    s_xor_b32 s7, s28, 1024
    buffer_load_dwordx4 v[68:71], v26, s[60:63], s7 offen sc1
    buffer_load_dwordx4 v[100:103], v27, s[60:63], s7 offen sc1
    s_xor_b32 s7, s28, 2048
    buffer_load_dwordx4 v[72:75], v26, s[60:63], s7 offen sc1
    buffer_load_dwordx4 v[104:107], v27, s[60:63], s7 offen sc1
    s_xor_b32 s7, s28, 3072
    buffer_load_dwordx4 v[76:79], v26, s[60:63], s7 offen sc1
    buffer_load_dwordx4 v[108:111], v27, s[60:63], s7 offen sc1
    s_xor_b32 s7, s28, 4096
    buffer_load_dwordx4 v[80:83], v26, s[60:63], s7 offen sc1
    buffer_load_dwordx4 v[112:115], v27, s[60:63], s7 offen sc1
    s_xor_b32 s7, s28, 5120
    buffer_load_dwordx4 v[84:87], v26, s[60:63], s7 offen sc1
    buffer_load_dwordx4 v[116:119], v27, s[60:63], s7 offen sc1
    s_xor_b32 s7, s28, 6144
    buffer_load_dwordx4 v[88:91], v26, s[60:63], s7 offen sc1
    buffer_load_dwordx4 v[120:123], v27, s[60:63], s7 offen sc1
    s_xor_b32 s7, s28, 7168
    buffer_load_dwordx4 v[92:95], v26, s[60:63], s7 offen sc1
    buffer_load_dwordx4 v[124:127], v27, s[60:63], s7 offen sc1
L_kvl2:
    s_setprio 3
    s_waitcnt vmcnt(9) lgkmcnt(0)
    v_mfma_f32_32x32x16_bf16 v[128:143], v[64:67], v[248:251], v[224:239]
    s_and_b32 s14, s15, 0x7ff
    s_lshr_b32 s8, s14, 5
    s_cmp_eq_u32 s8, s82
    s_cselect_b32 s78, 1, 0
    s_and_b32 s15, s15, 0xffff0000
    s_cmp_lt_u32 s3, 4
    s_cselect_b32 s8, s78, 0
    s_lshl_b32 s8, s8, 14
    s_or_b32 s71, s71, s8
    s_nop 3
L_attn:
    v_mov_b32 v52, 161812
    s_mov_b32 s12, 0
    s_cmp_ge_u32 s3, 4
    s_cbranch_scc1 L_nokv_3
    s_xor_b32 s7, s28, 5120
    buffer_load_dwordx4 v[84:87], v26, s[60:63], s7 offen sc1
    buffer_load_dwordx4 v[116:119], v27, s[60:63], s7 offen sc1
    s_xor_b32 s7, s28, 6144
    buffer_load_dwordx4 v[88:91], v26, s[60:63], s7 offen sc1
    buffer_load_dwordx4 v[120:123], v27, s[60:63], s7 offen sc1
    s_xor_b32 s7, s28, 7168
    buffer_load_dwordx4 v[92:95], v26, s[60:63], s7 offen sc1
    buffer_load_dwordx4 v[124:127], v27, s[60:63], s7 offen sc1
L_nokv_3:
    v_exp_f32 v128, v128
    v_exp_f32 v129, v129
    v_exp_f32 v130, v130
    v_exp_f32 v131, v131
    v_exp_f32 v132, v132
    v_exp_f32 v133, v133
    v_cvt_pk_bf16_f32 v240, v128, v129
    s_waitcnt vmcnt(13)
    v_mfma_f32_32x32x16_bf16 v[144:159], v[68:71], v[248:251], v[224:239]
    v_exp_f32 v134, v134
    v_exp_f32 v135, v135
    v_cvt_pk_bf16_f32 v241, v130, v131
    v_exp_f32 v136, v136
    v_exp_f32 v137, v137
    v_cvt_pk_bf16_f32 v242, v132, v133
    v_exp_f32 v138, v138
    v_exp_f32 v139, v139
    v_cvt_pk_bf16_f32 v243, v134, v135
    v_permlane16_swap_b32 v96, v192
    v_permlane16_swap_b32 v97, v193
    v_permlane16_swap_b32 v98, v194
    v_permlane16_swap_b32 v99, v195
    v_exp_f32 v140, v140
    v_exp_f32 v141, v141
    v_mfma_f32_32x32x16_bf16 v[160:175], v[96:99], v[240:243], 0
    v_cvt_pk_bf16_f32 v244, v136, v137
    v_exp_f32 v142, v142
    v_exp_f32 v143, v143
    v_cvt_pk_bf16_f32 v245, v138, v139
    v_cvt_pk_bf16_f32 v246, v140, v141
    v_cvt_pk_bf16_f32 v247, v142, v143
    v_exp_f32 v144, v144
    v_exp_f32 v145, v145
    v_mfma_f32_32x32x16_bf16 v[160:175], v[192:195], v[244:247], v[160:175]
    v_exp_f32 v146, v146
    v_exp_f32 v147, v147
    v_exp_f32 v148, v148
    v_exp_f32 v149, v149
    v_cvt_pk_bf16_f32 v240, v144, v145
    s_waitcnt vmcnt(11)
    v_mfma_f32_32x32x16_bf16 v[128:143], v[72:75], v[248:251], v[224:239]
    v_exp_f32 v150, v150
    v_exp_f32 v151, v151
    v_cvt_pk_bf16_f32 v241, v146, v147
    v_exp_f32 v152, v152
    v_exp_f32 v153, v153
    v_cvt_pk_bf16_f32 v242, v148, v149
    v_exp_f32 v154, v154
    v_exp_f32 v155, v155
    v_cvt_pk_bf16_f32 v243, v150, v151
    v_permlane16_swap_b32 v100, v196
    v_permlane16_swap_b32 v101, v197
    v_permlane16_swap_b32 v102, v198
    v_permlane16_swap_b32 v103, v199
    v_exp_f32 v156, v156
    v_exp_f32 v157, v157
    v_mfma_f32_32x32x16_bf16 v[160:175], v[100:103], v[240:243], v[160:175]
    v_cvt_pk_bf16_f32 v244, v152, v153
    v_exp_f32 v158, v158
    v_exp_f32 v159, v159
    v_cvt_pk_bf16_f32 v245, v154, v155
    v_cvt_pk_bf16_f32 v246, v156, v157
    v_cvt_pk_bf16_f32 v247, v158, v159
    v_exp_f32 v128, v128
    v_exp_f32 v129, v129
    v_mfma_f32_32x32x16_bf16 v[160:175], v[196:199], v[244:247], v[160:175]
    v_exp_f32 v130, v130
    v_exp_f32 v131, v131
    v_exp_f32 v132, v132
    v_exp_f32 v133, v133
    v_cvt_pk_bf16_f32 v240, v128, v129
    s_waitcnt vmcnt(9)
    v_mfma_f32_32x32x16_bf16 v[144:159], v[76:79], v[248:251], v[224:239]
    v_exp_f32 v134, v134
    v_exp_f32 v135, v135
    v_cvt_pk_bf16_f32 v241, v130, v131
    v_exp_f32 v136, v136
    v_exp_f32 v137, v137
    v_cvt_pk_bf16_f32 v242, v132, v133
    v_exp_f32 v138, v138
    v_exp_f32 v139, v139
    v_cvt_pk_bf16_f32 v243, v134, v135
    v_permlane16_swap_b32 v104, v200
    v_permlane16_swap_b32 v105, v201
    v_permlane16_swap_b32 v106, v202
    v_permlane16_swap_b32 v107, v203
    v_exp_f32 v140, v140
    v_exp_f32 v141, v141
    v_mfma_f32_32x32x16_bf16 v[160:175], v[104:107], v[240:243], v[160:175]
    v_cvt_pk_bf16_f32 v244, v136, v137
    v_exp_f32 v142, v142
    v_exp_f32 v143, v143
    v_cvt_pk_bf16_f32 v245, v138, v139
    v_cvt_pk_bf16_f32 v246, v140, v141
    v_cvt_pk_bf16_f32 v247, v142, v143
    v_exp_f32 v144, v144
    v_exp_f32 v145, v145
    v_mfma_f32_32x32x16_bf16 v[160:175], v[200:203], v[244:247], v[160:175]
    v_exp_f32 v146, v146
    v_exp_f32 v147, v147
    v_exp_f32 v148, v148
    v_exp_f32 v149, v149
    v_cvt_pk_bf16_f32 v240, v144, v145
    s_waitcnt vmcnt(7)
    v_mfma_f32_32x32x16_bf16 v[128:143], v[80:83], v[248:251], v[224:239]
    v_exp_f32 v150, v150
    v_exp_f32 v151, v151
    v_cvt_pk_bf16_f32 v241, v146, v147
    v_exp_f32 v152, v152
    v_exp_f32 v153, v153
    v_cvt_pk_bf16_f32 v242, v148, v149
    v_exp_f32 v154, v154
    v_exp_f32 v155, v155
    v_cvt_pk_bf16_f32 v243, v150, v151
    v_permlane16_swap_b32 v108, v204
    v_permlane16_swap_b32 v109, v205
    v_permlane16_swap_b32 v110, v206
    v_permlane16_swap_b32 v111, v207
    v_exp_f32 v156, v156
    v_exp_f32 v157, v157
    v_mfma_f32_32x32x16_bf16 v[160:175], v[108:111], v[240:243], v[160:175]
    v_cvt_pk_bf16_f32 v244, v152, v153
    v_exp_f32 v158, v158
    v_exp_f32 v159, v159
    v_cvt_pk_bf16_f32 v245, v154, v155
    v_cvt_pk_bf16_f32 v246, v156, v157
    v_cvt_pk_bf16_f32 v247, v158, v159
    v_exp_f32 v128, v128
    v_exp_f32 v129, v129
    v_mfma_f32_32x32x16_bf16 v[160:175], v[204:207], v[244:247], v[160:175]
    v_exp_f32 v130, v130
    v_exp_f32 v131, v131
    v_exp_f32 v132, v132
    v_exp_f32 v133, v133
    v_cvt_pk_bf16_f32 v240, v128, v129
    s_waitcnt vmcnt(5)
    v_mfma_f32_32x32x16_bf16 v[144:159], v[84:87], v[248:251], v[224:239]
    v_exp_f32 v134, v134
    v_exp_f32 v135, v135
    v_cvt_pk_bf16_f32 v241, v130, v131
    v_exp_f32 v136, v136
    v_exp_f32 v137, v137
    v_cvt_pk_bf16_f32 v242, v132, v133
    v_exp_f32 v138, v138
    v_exp_f32 v139, v139
    v_cvt_pk_bf16_f32 v243, v134, v135
    v_permlane16_swap_b32 v112, v208
    v_permlane16_swap_b32 v113, v209
    v_permlane16_swap_b32 v114, v210
    v_permlane16_swap_b32 v115, v211
    v_exp_f32 v140, v140
    v_exp_f32 v141, v141
    v_mfma_f32_32x32x16_bf16 v[160:175], v[112:115], v[240:243], v[160:175]
    v_cvt_pk_bf16_f32 v244, v136, v137
    v_exp_f32 v142, v142
    v_exp_f32 v143, v143
    v_cvt_pk_bf16_f32 v245, v138, v139
    v_cvt_pk_bf16_f32 v246, v140, v141
    v_cvt_pk_bf16_f32 v247, v142, v143
    v_exp_f32 v144, v144
    v_exp_f32 v145, v145
    v_mfma_f32_32x32x16_bf16 v[160:175], v[208:211], v[244:247], v[160:175]
    v_exp_f32 v146, v146
    v_exp_f32 v147, v147
    v_exp_f32 v148, v148
    v_exp_f32 v149, v149
    v_cvt_pk_bf16_f32 v240, v144, v145
    s_waitcnt vmcnt(3)
    v_mfma_f32_32x32x16_bf16 v[128:143], v[88:91], v[248:251], v[224:239]
    v_exp_f32 v150, v150
    v_exp_f32 v151, v151
    v_cvt_pk_bf16_f32 v241, v146, v147
    v_exp_f32 v152, v152
    v_exp_f32 v153, v153
    v_cvt_pk_bf16_f32 v242, v148, v149
    v_exp_f32 v154, v154
    v_exp_f32 v155, v155
    v_cvt_pk_bf16_f32 v243, v150, v151
    v_permlane16_swap_b32 v116, v212
    v_permlane16_swap_b32 v117, v213
    v_permlane16_swap_b32 v118, v214
    v_permlane16_swap_b32 v119, v215
    v_exp_f32 v156, v156
    v_exp_f32 v157, v157
    v_mfma_f32_32x32x16_bf16 v[160:175], v[116:119], v[240:243], v[160:175]
    v_cvt_pk_bf16_f32 v244, v152, v153
    v_exp_f32 v158, v158
    v_exp_f32 v159, v159
    v_cvt_pk_bf16_f32 v245, v154, v155
    v_cvt_pk_bf16_f32 v246, v156, v157
    v_cvt_pk_bf16_f32 v247, v158, v159
    v_exp_f32 v128, v128
    v_exp_f32 v129, v129
    v_mfma_f32_32x32x16_bf16 v[160:175], v[212:215], v[244:247], v[160:175]
    v_exp_f32 v130, v130
    v_exp_f32 v131, v131
    v_exp_f32 v132, v132
    v_exp_f32 v133, v133
    v_cvt_pk_bf16_f32 v240, v128, v129
    s_waitcnt vmcnt(1)
    v_mfma_f32_32x32x16_bf16 v[144:159], v[92:95], v[248:251], v[224:239]
    v_exp_f32 v134, v134
    v_exp_f32 v135, v135
    v_cvt_pk_bf16_f32 v241, v130, v131
    v_exp_f32 v136, v136
    v_exp_f32 v137, v137
    v_cvt_pk_bf16_f32 v242, v132, v133
    v_exp_f32 v138, v138
    v_exp_f32 v139, v139
    v_cvt_pk_bf16_f32 v243, v134, v135
    v_permlane16_swap_b32 v120, v216
    v_permlane16_swap_b32 v121, v217
    v_permlane16_swap_b32 v122, v218
    v_permlane16_swap_b32 v123, v219
    ds_read_b128 v[248:251], v253
    v_exp_f32 v140, v140
    v_exp_f32 v141, v141
    v_mfma_f32_32x32x16_bf16 v[160:175], v[120:123], v[240:243], v[160:175]
    v_cvt_pk_bf16_f32 v244, v136, v137
    v_exp_f32 v142, v142
    v_exp_f32 v143, v143
    v_cvt_pk_bf16_f32 v245, v138, v139
    v_cvt_pk_bf16_f32 v246, v140, v141
    v_cvt_pk_bf16_f32 v247, v142, v143
    s_waitcnt lgkmcnt(0)
    s_cmp_eq_u32 s13, 0
    s_cbranch_scc0 L_fbc_1
L_fbr_1:
L_ok_0:
    v_exp_f32 v144, v144
    v_exp_f32 v145, v145
    v_mfma_f32_32x32x16_bf16 v[160:175], v[216:219], v[244:247], v[160:175]
    v_exp_f32 v146, v146
    v_exp_f32 v147, v147
    v_exp_f32 v148, v148
    v_exp_f32 v149, v149
    v_cvt_pk_bf16_f32 v240, v144, v145
    v_mfma_f32_32x32x16_bf16 v[128:143], v[64:67], v[248:251], v[224:239]
    v_exp_f32 v150, v150
    v_exp_f32 v151, v151
    v_cvt_pk_bf16_f32 v241, v146, v147
    v_exp_f32 v152, v152
    v_exp_f32 v153, v153
    v_cvt_pk_bf16_f32 v242, v148, v149
    v_exp_f32 v154, v154
    v_exp_f32 v155, v155
    v_cvt_pk_bf16_f32 v243, v150, v151
    s_waitcnt vmcnt(0)
    v_permlane16_swap_b32 v124, v220
    v_permlane16_swap_b32 v125, v221
    v_permlane16_swap_b32 v126, v222
    v_permlane16_swap_b32 v127, v223
    v_exp_f32 v156, v156
    v_exp_f32 v157, v157
    v_mfma_f32_32x32x16_bf16 v[160:175], v[124:127], v[240:243], v[160:175]
    v_cvt_pk_bf16_f32 v244, v152, v153
    v_exp_f32 v158, v158
    v_exp_f32 v159, v159
    v_cvt_pk_bf16_f32 v245, v154, v155
    v_cvt_pk_bf16_f32 v246, v156, v157
    v_cvt_pk_bf16_f32 v247, v158, v159
    v_exp_f32 v128, v128
    v_exp_f32 v129, v129
    v_mfma_f32_32x32x16_bf16 v[160:175], v[220:223], v[244:247], v[160:175]
    v_exp_f32 v130, v130
    v_exp_f32 v131, v131
    v_exp_f32 v132, v132
    v_exp_f32 v133, v133
    v_cvt_pk_bf16_f32 v240, v128, v129
    v_mfma_f32_32x32x16_bf16 v[144:159], v[68:71], v[248:251], v[224:239]
    v_exp_f32 v134, v134
    v_exp_f32 v135, v135
    v_cvt_pk_bf16_f32 v241, v130, v131
    v_exp_f32 v136, v136
    v_exp_f32 v137, v137
    v_cvt_pk_bf16_f32 v242, v132, v133
    v_exp_f32 v138, v138
    v_exp_f32 v139, v139
    v_cvt_pk_bf16_f32 v243, v134, v135
    v_exp_f32 v140, v140
    v_exp_f32 v141, v141
    v_mfma_f32_32x32x16_bf16 v[176:191], v[96:99], v[240:243], 0
    v_cvt_pk_bf16_f32 v244, v136, v137
    v_exp_f32 v142, v142
    v_exp_f32 v143, v143
    v_cvt_pk_bf16_f32 v245, v138, v139
    v_cvt_pk_bf16_f32 v246, v140, v141
    v_cvt_pk_bf16_f32 v247, v142, v143
    v_mov_b32 v169, 1
    ds_write_b128 v54, v[160:163]
    ds_write_b128 v54, v[164:167] offset:1024
    ds_write_b64 v59, v[168:169]
    s_bitcmp1_b32 s71, 2
    s_cbranch_scc1 L_hook2
L_hret2:
    v_exp_f32 v144, v144
    v_exp_f32 v145, v145
    v_mfma_f32_32x32x16_bf16 v[176:191], v[192:195], v[244:247], v[176:191]
    v_exp_f32 v146, v146
    v_exp_f32 v147, v147
    v_exp_f32 v148, v148
    v_exp_f32 v149, v149
    v_cvt_pk_bf16_f32 v240, v144, v145
    v_mfma_f32_32x32x16_bf16 v[128:143], v[72:75], v[248:251], v[224:239]
    v_exp_f32 v150, v150
    v_exp_f32 v151, v151
    v_cvt_pk_bf16_f32 v241, v146, v147
    v_exp_f32 v152, v152
    v_exp_f32 v153, v153
    v_cvt_pk_bf16_f32 v242, v148, v149
    v_exp_f32 v154, v154
    v_exp_f32 v155, v155
    v_cvt_pk_bf16_f32 v243, v150, v151
    v_exp_f32 v156, v156
    v_exp_f32 v157, v157
    v_mfma_f32_32x32x16_bf16 v[176:191], v[100:103], v[240:243], v[176:191]
    v_cvt_pk_bf16_f32 v244, v152, v153
    v_exp_f32 v158, v158
    v_exp_f32 v159, v159
    v_cvt_pk_bf16_f32 v245, v154, v155
    v_cvt_pk_bf16_f32 v246, v156, v157
    v_cvt_pk_bf16_f32 v247, v158, v159
    v_exp_f32 v128, v128
    v_exp_f32 v129, v129
    v_mfma_f32_32x32x16_bf16 v[176:191], v[196:199], v[244:247], v[176:191]
    v_exp_f32 v130, v130
    v_exp_f32 v131, v131
    v_exp_f32 v132, v132
    v_exp_f32 v133, v133
    v_cvt_pk_bf16_f32 v240, v128, v129
    v_mfma_f32_32x32x16_bf16 v[144:159], v[76:79], v[248:251], v[224:239]
    v_exp_f32 v134, v134
    v_exp_f32 v135, v135
    v_cvt_pk_bf16_f32 v241, v130, v131
    v_exp_f32 v136, v136
    v_exp_f32 v137, v137
    v_cvt_pk_bf16_f32 v242, v132, v133
    v_exp_f32 v138, v138
    v_exp_f32 v139, v139
    v_cvt_pk_bf16_f32 v243, v134, v135
    v_exp_f32 v140, v140
    v_exp_f32 v141, v141
    v_mfma_f32_32x32x16_bf16 v[176:191], v[104:107], v[240:243], v[176:191]
    v_cvt_pk_bf16_f32 v244, v136, v137
    v_exp_f32 v142, v142
    v_exp_f32 v143, v143
    v_cvt_pk_bf16_f32 v245, v138, v139
    v_cvt_pk_bf16_f32 v246, v140, v141
    v_cvt_pk_bf16_f32 v247, v142, v143
    v_exp_f32 v144, v144
    v_exp_f32 v145, v145
    v_mfma_f32_32x32x16_bf16 v[176:191], v[200:203], v[244:247], v[176:191]
    v_exp_f32 v146, v146
    v_exp_f32 v147, v147
    v_exp_f32 v148, v148
    v_exp_f32 v149, v149
    v_cvt_pk_bf16_f32 v240, v144, v145
    v_mfma_f32_32x32x16_bf16 v[128:143], v[80:83], v[248:251], v[224:239]
    v_exp_f32 v150, v150
    v_exp_f32 v151, v151
    v_cvt_pk_bf16_f32 v241, v146, v147
    v_exp_f32 v152, v152
    v_exp_f32 v153, v153
    v_cvt_pk_bf16_f32 v242, v148, v149
    v_exp_f32 v154, v154
    v_exp_f32 v155, v155
    v_cvt_pk_bf16_f32 v243, v150, v151
    v_exp_f32 v156, v156
    v_exp_f32 v157, v157
    v_mfma_f32_32x32x16_bf16 v[176:191], v[108:111], v[240:243], v[176:191]
    v_cvt_pk_bf16_f32 v244, v152, v153
    v_exp_f32 v158, v158
    v_exp_f32 v159, v159
    v_cvt_pk_bf16_f32 v245, v154, v155
    v_cvt_pk_bf16_f32 v246, v156, v157
    v_cvt_pk_bf16_f32 v247, v158, v159
    v_exp_f32 v128, v128
    v_exp_f32 v129, v129
    v_mfma_f32_32x32x16_bf16 v[176:191], v[204:207], v[244:247], v[176:191]
    v_exp_f32 v130, v130
    v_exp_f32 v131, v131
    v_exp_f32 v132, v132
    v_exp_f32 v133, v133
    v_cvt_pk_bf16_f32 v240, v128, v129
    v_mfma_f32_32x32x16_bf16 v[144:159], v[84:87], v[248:251], v[224:239]
    v_exp_f32 v134, v134
    v_exp_f32 v135, v135
    v_cvt_pk_bf16_f32 v241, v130, v131
    v_exp_f32 v136, v136
    v_exp_f32 v137, v137
    v_cvt_pk_bf16_f32 v242, v132, v133
    v_exp_f32 v138, v138
    v_exp_f32 v139, v139
    v_cvt_pk_bf16_f32 v243, v134, v135
    v_exp_f32 v140, v140
    v_exp_f32 v141, v141
    v_mfma_f32_32x32x16_bf16 v[176:191], v[112:115], v[240:243], v[176:191]
    v_cvt_pk_bf16_f32 v244, v136, v137
    v_exp_f32 v142, v142
    v_exp_f32 v143, v143
    v_cvt_pk_bf16_f32 v245, v138, v139
    v_cvt_pk_bf16_f32 v246, v140, v141
    v_cvt_pk_bf16_f32 v247, v142, v143
    s_bitcmp1_b32 s71, 3
    s_cbranch_scc1 L_hook3
L_hret3:
    v_exp_f32 v144, v144
    v_exp_f32 v145, v145
    v_mfma_f32_32x32x16_bf16 v[176:191], v[208:211], v[244:247], v[176:191]
    v_exp_f32 v146, v146
    v_exp_f32 v147, v147
    v_exp_f32 v148, v148
    v_exp_f32 v149, v149
    v_cvt_pk_bf16_f32 v240, v144, v145
    v_mfma_f32_32x32x16_bf16 v[128:143], v[88:91], v[248:251], v[224:239]
    v_exp_f32 v150, v150
    v_exp_f32 v151, v151
    v_cvt_pk_bf16_f32 v241, v146, v147
    v_exp_f32 v152, v152
    v_exp_f32 v153, v153
    v_cvt_pk_bf16_f32 v242, v148, v149
    v_exp_f32 v154, v154
    v_exp_f32 v155, v155
    v_cvt_pk_bf16_f32 v243, v150, v151
    ds_read_b64 v[168:169], v60
    ds_read_b128 v[160:163], v55
    ds_read_b128 v[164:167], v55 offset:1024
    v_exp_f32 v156, v156
    v_exp_f32 v157, v157
    v_mfma_f32_32x32x16_bf16 v[176:191], v[116:119], v[240:243], v[176:191]
    v_cvt_pk_bf16_f32 v244, v152, v153
    v_exp_f32 v158, v158
    v_exp_f32 v159, v159
    v_cvt_pk_bf16_f32 v245, v154, v155
    v_cvt_pk_bf16_f32 v246, v156, v157
    v_cvt_pk_bf16_f32 v247, v158, v159
    v_exp_f32 v128, v128
    v_exp_f32 v129, v129
    v_mfma_f32_32x32x16_bf16 v[176:191], v[212:215], v[244:247], v[176:191]
    v_exp_f32 v130, v130
    v_exp_f32 v131, v131
    v_exp_f32 v132, v132
    v_exp_f32 v133, v133
    v_cvt_pk_bf16_f32 v240, v128, v129
    v_mfma_f32_32x32x16_bf16 v[144:159], v[92:95], v[248:251], v[224:239]
    v_exp_f32 v134, v134
    v_exp_f32 v135, v135
    v_cvt_pk_bf16_f32 v241, v130, v131
    v_exp_f32 v136, v136
    v_exp_f32 v137, v137
    v_cvt_pk_bf16_f32 v242, v132, v133
    v_exp_f32 v138, v138
    v_exp_f32 v139, v139
    v_cvt_pk_bf16_f32 v243, v134, v135
    ds_read_b128 v[248:251], v254
    v_exp_f32 v140, v140
    v_exp_f32 v141, v141
    v_mfma_f32_32x32x16_bf16 v[176:191], v[120:123], v[240:243], v[176:191]
    v_cvt_pk_bf16_f32 v244, v136, v137
    v_exp_f32 v142, v142
    v_exp_f32 v143, v143
    v_cvt_pk_bf16_f32 v245, v138, v139
    v_cvt_pk_bf16_f32 v246, v140, v141
    v_cvt_pk_bf16_f32 v247, v142, v143
    s_waitcnt lgkmcnt(0)
    v_cmp_ne_u32 vcc, 1, v169
    s_cmp_eq_u32 s13, 0
    s_cbranch_scc0 L_fbc_2
L_fbr_2:
    s_cbranch_vccnz L_retry_1
L_ok_1:
    v_exp_f32 v144, v144
    v_exp_f32 v145, v145
    v_mfma_f32_32x32x16_bf16 v[176:191], v[216:219], v[244:247], v[176:191]
    v_exp_f32 v146, v146
    v_exp_f32 v147, v147
    v_exp_f32 v148, v148
    v_exp_f32 v149, v149
    v_cvt_pk_bf16_f32 v240, v144, v145
    v_mfma_f32_32x32x16_bf16 v[128:143], v[64:67], v[248:251], v[224:239]
    v_exp_f32 v150, v150
    v_exp_f32 v151, v151
    v_cvt_pk_bf16_f32 v241, v146, v147
    v_exp_f32 v152, v152
    v_exp_f32 v153, v153
    v_cvt_pk_bf16_f32 v242, v148, v149
    v_exp_f32 v154, v154
    v_exp_f32 v155, v155
    v_cvt_pk_bf16_f32 v243, v150, v151
    v_exp_f32 v156, v156
    v_exp_f32 v157, v157
    v_mfma_f32_32x32x16_bf16 v[176:191], v[124:127], v[240:243], v[176:191]
    v_cvt_pk_bf16_f32 v244, v152, v153
    v_exp_f32 v158, v158
    v_exp_f32 v159, v159
    v_cvt_pk_bf16_f32 v245, v154, v155
    v_cvt_pk_bf16_f32 v246, v156, v157
    v_cvt_pk_bf16_f32 v247, v158, v159
    v_exp_f32 v128, v128
    v_exp_f32 v129, v129
    v_mfma_f32_32x32x16_bf16 v[176:191], v[220:223], v[244:247], v[176:191]
    v_exp_f32 v130, v130
    v_exp_f32 v131, v131
    v_exp_f32 v132, v132
    v_exp_f32 v133, v133
    v_cvt_pk_bf16_f32 v240, v128, v129
    v_mfma_f32_32x32x16_bf16 v[144:159], v[68:71], v[248:251], v[224:239]
    v_exp_f32 v134, v134
    v_exp_f32 v135, v135
    v_cvt_pk_bf16_f32 v241, v130, v131
    v_exp_f32 v136, v136
    v_exp_f32 v137, v137
    v_cvt_pk_bf16_f32 v242, v132, v133
    v_exp_f32 v138, v138
    v_exp_f32 v139, v139
    v_cvt_pk_bf16_f32 v243, v134, v135
    v_exp_f32 v140, v140
    v_exp_f32 v141, v141
    v_mfma_f32_32x32x16_bf16 v[160:175], v[96:99], v[240:243], v[160:175]
    v_cvt_pk_bf16_f32 v244, v136, v137
    v_exp_f32 v142, v142
    v_exp_f32 v143, v143
    v_cvt_pk_bf16_f32 v245, v138, v139
    v_cvt_pk_bf16_f32 v246, v140, v141
    v_cvt_pk_bf16_f32 v247, v142, v143
    v_mov_b32 v185, 2
    ds_write_b128 v55, v[176:179]
    ds_write_b128 v55, v[180:183] offset:1024
    ds_write_b64 v60, v[184:185]
    s_bitcmp1_b32 s71, 4
    s_cbranch_scc1 L_hook4
L_hret4:
    v_exp_f32 v144, v144
    v_exp_f32 v145, v145
    v_mfma_f32_32x32x16_bf16 v[160:175], v[192:195], v[244:247], v[160:175]
    v_exp_f32 v146, v146
    v_exp_f32 v147, v147
    v_exp_f32 v148, v148
    v_exp_f32 v149, v149
    v_cvt_pk_bf16_f32 v240, v144, v145
    v_mfma_f32_32x32x16_bf16 v[128:143], v[72:75], v[248:251], v[224:239]
    v_exp_f32 v150, v150
    v_exp_f32 v151, v151
    v_cvt_pk_bf16_f32 v241, v146, v147
    v_exp_f32 v152, v152
    v_exp_f32 v153, v153
    v_cvt_pk_bf16_f32 v242, v148, v149
    v_exp_f32 v154, v154
    v_exp_f32 v155, v155
    v_cvt_pk_bf16_f32 v243, v150, v151
    v_exp_f32 v156, v156
    v_exp_f32 v157, v157
    v_mfma_f32_32x32x16_bf16 v[160:175], v[100:103], v[240:243], v[160:175]
    v_cvt_pk_bf16_f32 v244, v152, v153
    v_exp_f32 v158, v158
    v_exp_f32 v159, v159
    v_cvt_pk_bf16_f32 v245, v154, v155
    v_cvt_pk_bf16_f32 v246, v156, v157
    v_cvt_pk_bf16_f32 v247, v158, v159
    v_exp_f32 v128, v128
    v_exp_f32 v129, v129
    v_mfma_f32_32x32x16_bf16 v[160:175], v[196:199], v[244:247], v[160:175]
    v_exp_f32 v130, v130
    v_exp_f32 v131, v131
    v_exp_f32 v132, v132
    v_exp_f32 v133, v133
    v_cvt_pk_bf16_f32 v240, v128, v129
    v_mfma_f32_32x32x16_bf16 v[144:159], v[76:79], v[248:251], v[224:239]
    v_exp_f32 v134, v134
    v_exp_f32 v135, v135
    v_cvt_pk_bf16_f32 v241, v130, v131
    v_exp_f32 v136, v136
    v_exp_f32 v137, v137
    v_cvt_pk_bf16_f32 v242, v132, v133
    v_exp_f32 v138, v138
    v_exp_f32 v139, v139
    v_cvt_pk_bf16_f32 v243, v134, v135
    v_exp_f32 v140, v140
    v_exp_f32 v141, v141
    v_mfma_f32_32x32x16_bf16 v[160:175], v[104:107], v[240:243], v[160:175]
    v_cvt_pk_bf16_f32 v244, v136, v137
    v_exp_f32 v142, v142
    v_exp_f32 v143, v143
    v_cvt_pk_bf16_f32 v245, v138, v139
    v_cvt_pk_bf16_f32 v246, v140, v141
    v_cvt_pk_bf16_f32 v247, v142, v143
    v_exp_f32 v144, v144
    v_exp_f32 v145, v145
    v_mfma_f32_32x32x16_bf16 v[160:175], v[200:203], v[244:247], v[160:175]
    v_exp_f32 v146, v146
    v_exp_f32 v147, v147
    v_exp_f32 v148, v148
    v_exp_f32 v149, v149
    v_cvt_pk_bf16_f32 v240, v144, v145
    v_mfma_f32_32x32x16_bf16 v[128:143], v[80:83], v[248:251], v[224:239]
    v_exp_f32 v150, v150
    v_exp_f32 v151, v151
    v_cvt_pk_bf16_f32 v241, v146, v147
    v_exp_f32 v152, v152
    v_exp_f32 v153, v153
    v_cvt_pk_bf16_f32 v242, v148, v149
    v_exp_f32 v154, v154
    v_exp_f32 v155, v155
    v_cvt_pk_bf16_f32 v243, v150, v151
    v_exp_f32 v156, v156
    v_exp_f32 v157, v157
    v_mfma_f32_32x32x16_bf16 v[160:175], v[108:111], v[240:243], v[160:175]
    v_cvt_pk_bf16_f32 v244, v152, v153
    v_exp_f32 v158, v158
    v_exp_f32 v159, v159
    v_cvt_pk_bf16_f32 v245, v154, v155
    v_cvt_pk_bf16_f32 v246, v156, v157
    v_cvt_pk_bf16_f32 v247, v158, v159
    v_exp_f32 v128, v128
    v_exp_f32 v129, v129
    v_mfma_f32_32x32x16_bf16 v[160:175], v[204:207], v[244:247], v[160:175]
    v_exp_f32 v130, v130
    v_exp_f32 v131, v131
    v_exp_f32 v132, v132
    v_exp_f32 v133, v133
    v_cvt_pk_bf16_f32 v240, v128, v129
    v_mfma_f32_32x32x16_bf16 v[144:159], v[84:87], v[248:251], v[224:239]
    v_exp_f32 v134, v134
    v_exp_f32 v135, v135
    v_cvt_pk_bf16_f32 v241, v130, v131
    v_exp_f32 v136, v136
    v_exp_f32 v137, v137
    v_cvt_pk_bf16_f32 v242, v132, v133
    v_exp_f32 v138, v138
    v_exp_f32 v139, v139
    v_cvt_pk_bf16_f32 v243, v134, v135
    v_exp_f32 v140, v140
    v_exp_f32 v141, v141
    v_mfma_f32_32x32x16_bf16 v[160:175], v[112:115], v[240:243], v[160:175]
    v_cvt_pk_bf16_f32 v244, v136, v137
    v_exp_f32 v142, v142
    v_exp_f32 v143, v143
    v_cvt_pk_bf16_f32 v245, v138, v139
    v_cvt_pk_bf16_f32 v246, v140, v141
    v_cvt_pk_bf16_f32 v247, v142, v143
    s_bitcmp1_b32 s71, 5
    s_cbranch_scc1 L_hook5
L_hret5:
    v_exp_f32 v144, v144
    v_exp_f32 v145, v145
    v_mfma_f32_32x32x16_bf16 v[160:175], v[208:211], v[244:247], v[160:175]
    v_exp_f32 v146, v146
    v_exp_f32 v147, v147
    v_exp_f32 v148, v148
    v_exp_f32 v149, v149
    v_cvt_pk_bf16_f32 v240, v144, v145
    v_mfma_f32_32x32x16_bf16 v[128:143], v[88:91], v[248:251], v[224:239]
    v_exp_f32 v150, v150
    v_exp_f32 v151, v151
    v_cvt_pk_bf16_f32 v241, v146, v147
    v_exp_f32 v152, v152
    v_exp_f32 v153, v153
    v_cvt_pk_bf16_f32 v242, v148, v149
    v_exp_f32 v154, v154
    v_exp_f32 v155, v155
    v_cvt_pk_bf16_f32 v243, v150, v151
    ds_read_b64 v[184:185], v61
    ds_read_b128 v[176:179], v56
    ds_read_b128 v[180:183], v56 offset:1024
    v_exp_f32 v156, v156
    v_exp_f32 v157, v157
    v_mfma_f32_32x32x16_bf16 v[160:175], v[116:119], v[240:243], v[160:175]
    v_cvt_pk_bf16_f32 v244, v152, v153
    v_exp_f32 v158, v158
    v_exp_f32 v159, v159
    v_cvt_pk_bf16_f32 v245, v154, v155
    v_cvt_pk_bf16_f32 v246, v156, v157
    v_cvt_pk_bf16_f32 v247, v158, v159
    v_exp_f32 v128, v128
    v_exp_f32 v129, v129
    v_mfma_f32_32x32x16_bf16 v[160:175], v[212:215], v[244:247], v[160:175]
    v_exp_f32 v130, v130
    v_exp_f32 v131, v131
    v_exp_f32 v132, v132
    v_exp_f32 v133, v133
    v_cvt_pk_bf16_f32 v240, v128, v129
    v_mfma_f32_32x32x16_bf16 v[144:159], v[92:95], v[248:251], v[224:239]
    v_exp_f32 v134, v134
    v_exp_f32 v135, v135
    v_cvt_pk_bf16_f32 v241, v130, v131
    v_exp_f32 v136, v136
    v_exp_f32 v137, v137
    v_cvt_pk_bf16_f32 v242, v132, v133
    v_exp_f32 v138, v138
    v_exp_f32 v139, v139
    v_cvt_pk_bf16_f32 v243, v134, v135
    ds_read_b128 v[248:251], v255
    v_exp_f32 v140, v140
    v_exp_f32 v141, v141
    v_mfma_f32_32x32x16_bf16 v[160:175], v[120:123], v[240:243], v[160:175]
    v_cvt_pk_bf16_f32 v244, v136, v137
    v_exp_f32 v142, v142
    v_exp_f32 v143, v143
    v_cvt_pk_bf16_f32 v245, v138, v139
    v_cvt_pk_bf16_f32 v246, v140, v141
    v_cvt_pk_bf16_f32 v247, v142, v143
    s_waitcnt lgkmcnt(0)
    v_cmp_ne_u32 vcc, 2, v185
    s_cmp_eq_u32 s13, 0
    s_cbranch_scc0 L_fbc_3
L_fbr_3:
    s_cbranch_vccnz L_retry_2
L_ok_2:
    v_exp_f32 v144, v144
    v_exp_f32 v145, v145
    v_mfma_f32_32x32x16_bf16 v[160:175], v[216:219], v[244:247], v[160:175]
    v_exp_f32 v146, v146
    v_exp_f32 v147, v147
    v_exp_f32 v148, v148
    v_exp_f32 v149, v149
    v_cvt_pk_bf16_f32 v240, v144, v145
    v_mfma_f32_32x32x16_bf16 v[128:143], v[64:67], v[248:251], v[224:239]
    v_exp_f32 v150, v150
    v_exp_f32 v151, v151
    v_cvt_pk_bf16_f32 v241, v146, v147
    v_exp_f32 v152, v152
    v_exp_f32 v153, v153
    v_cvt_pk_bf16_f32 v242, v148, v149
    v_exp_f32 v154, v154
    v_exp_f32 v155, v155
    v_cvt_pk_bf16_f32 v243, v150, v151
    v_exp_f32 v156, v156
    v_exp_f32 v157, v157
    v_mfma_f32_32x32x16_bf16 v[160:175], v[124:127], v[240:243], v[160:175]
    v_cvt_pk_bf16_f32 v244, v152, v153
    v_exp_f32 v158, v158
    v_exp_f32 v159, v159
    v_cvt_pk_bf16_f32 v245, v154, v155
    v_cvt_pk_bf16_f32 v246, v156, v157
    v_cvt_pk_bf16_f32 v247, v158, v159
    v_exp_f32 v128, v128
    v_exp_f32 v129, v129
    v_mfma_f32_32x32x16_bf16 v[160:175], v[220:223], v[244:247], v[160:175]
    v_exp_f32 v130, v130
    v_exp_f32 v131, v131
    v_exp_f32 v132, v132
    v_exp_f32 v133, v133
    v_cvt_pk_bf16_f32 v240, v128, v129
    v_mfma_f32_32x32x16_bf16 v[144:159], v[68:71], v[248:251], v[224:239]
    v_exp_f32 v134, v134
    v_exp_f32 v135, v135
    v_cvt_pk_bf16_f32 v241, v130, v131
    v_exp_f32 v136, v136
    v_exp_f32 v137, v137
    v_cvt_pk_bf16_f32 v242, v132, v133
    v_exp_f32 v138, v138
    v_exp_f32 v139, v139
    v_cvt_pk_bf16_f32 v243, v134, v135
    v_exp_f32 v140, v140
    v_exp_f32 v141, v141
    v_mfma_f32_32x32x16_bf16 v[176:191], v[96:99], v[240:243], v[176:191]
    v_cvt_pk_bf16_f32 v244, v136, v137
    v_exp_f32 v142, v142
    v_exp_f32 v143, v143
    v_cvt_pk_bf16_f32 v245, v138, v139
    v_cvt_pk_bf16_f32 v246, v140, v141
    v_cvt_pk_bf16_f32 v247, v142, v143
    v_mov_b32 v169, 3
    ds_write_b128 v56, v[160:163]
    ds_write_b128 v56, v[164:167] offset:1024
    ds_write_b64 v61, v[168:169]
    s_bitcmp1_b32 s71, 6
    s_cbranch_scc1 L_hook6
L_hret6:
    v_exp_f32 v144, v144
    v_exp_f32 v145, v145
    v_mfma_f32_32x32x16_bf16 v[176:191], v[192:195], v[244:247], v[176:191]
    v_exp_f32 v146, v146
    v_exp_f32 v147, v147
    v_exp_f32 v148, v148
    v_exp_f32 v149, v149
    v_cvt_pk_bf16_f32 v240, v144, v145
    v_mfma_f32_32x32x16_bf16 v[128:143], v[72:75], v[248:251], v[224:239]
    v_exp_f32 v150, v150
    v_exp_f32 v151, v151
    v_cvt_pk_bf16_f32 v241, v146, v147
    v_exp_f32 v152, v152
    v_exp_f32 v153, v153
    v_cvt_pk_bf16_f32 v242, v148, v149
    v_exp_f32 v154, v154
    v_exp_f32 v155, v155
    v_cvt_pk_bf16_f32 v243, v150, v151
    v_exp_f32 v156, v156
    v_exp_f32 v157, v157
    v_mfma_f32_32x32x16_bf16 v[176:191], v[100:103], v[240:243], v[176:191]
    v_cvt_pk_bf16_f32 v244, v152, v153
    v_exp_f32 v158, v158
    v_exp_f32 v159, v159
    v_cvt_pk_bf16_f32 v245, v154, v155
    v_cvt_pk_bf16_f32 v246, v156, v157
    v_cvt_pk_bf16_f32 v247, v158, v159
    v_exp_f32 v128, v128
    v_exp_f32 v129, v129
    v_mfma_f32_32x32x16_bf16 v[176:191], v[196:199], v[244:247], v[176:191]
    v_exp_f32 v130, v130
    v_exp_f32 v131, v131
    v_exp_f32 v132, v132
    v_exp_f32 v133, v133
    v_cvt_pk_bf16_f32 v240, v128, v129
    v_mfma_f32_32x32x16_bf16 v[144:159], v[76:79], v[248:251], v[224:239]
    v_exp_f32 v134, v134
    v_exp_f32 v135, v135
    v_cvt_pk_bf16_f32 v241, v130, v131
    v_exp_f32 v136, v136
    v_exp_f32 v137, v137
    v_cvt_pk_bf16_f32 v242, v132, v133
    v_exp_f32 v138, v138
    v_exp_f32 v139, v139
    v_cvt_pk_bf16_f32 v243, v134, v135
    v_exp_f32 v140, v140
    v_exp_f32 v141, v141
    v_mfma_f32_32x32x16_bf16 v[176:191], v[104:107], v[240:243], v[176:191]
    v_cvt_pk_bf16_f32 v244, v136, v137
    v_exp_f32 v142, v142
    v_exp_f32 v143, v143
    v_cvt_pk_bf16_f32 v245, v138, v139
    v_cvt_pk_bf16_f32 v246, v140, v141
    v_cvt_pk_bf16_f32 v247, v142, v143
    v_exp_f32 v144, v144
    v_exp_f32 v145, v145
    v_mfma_f32_32x32x16_bf16 v[176:191], v[200:203], v[244:247], v[176:191]
    v_exp_f32 v146, v146
    v_exp_f32 v147, v147
    v_exp_f32 v148, v148
    v_exp_f32 v149, v149
    v_cvt_pk_bf16_f32 v240, v144, v145
    v_mfma_f32_32x32x16_bf16 v[128:143], v[80:83], v[248:251], v[224:239]
    v_exp_f32 v150, v150
    v_exp_f32 v151, v151
    v_cvt_pk_bf16_f32 v241, v146, v147
    v_exp_f32 v152, v152
    v_exp_f32 v153, v153
    v_cvt_pk_bf16_f32 v242, v148, v149
    v_exp_f32 v154, v154
    v_exp_f32 v155, v155
    v_cvt_pk_bf16_f32 v243, v150, v151
    v_exp_f32 v156, v156
    v_exp_f32 v157, v157
    v_mfma_f32_32x32x16_bf16 v[176:191], v[108:111], v[240:243], v[176:191]
    v_cvt_pk_bf16_f32 v244, v152, v153
    v_exp_f32 v158, v158
    v_exp_f32 v159, v159
    v_cvt_pk_bf16_f32 v245, v154, v155
    v_cvt_pk_bf16_f32 v246, v156, v157
    v_cvt_pk_bf16_f32 v247, v158, v159
    v_exp_f32 v128, v128
    v_exp_f32 v129, v129
    v_mfma_f32_32x32x16_bf16 v[176:191], v[204:207], v[244:247], v[176:191]
    v_exp_f32 v130, v130
    v_exp_f32 v131, v131
    v_exp_f32 v132, v132
    v_exp_f32 v133, v133
    v_cvt_pk_bf16_f32 v240, v128, v129
    v_mfma_f32_32x32x16_bf16 v[144:159], v[84:87], v[248:251], v[224:239]
    v_exp_f32 v134, v134
    v_exp_f32 v135, v135
    v_cvt_pk_bf16_f32 v241, v130, v131
    v_exp_f32 v136, v136
    v_exp_f32 v137, v137
    v_cvt_pk_bf16_f32 v242, v132, v133
    v_exp_f32 v138, v138
    v_exp_f32 v139, v139
    v_cvt_pk_bf16_f32 v243, v134, v135
    v_exp_f32 v140, v140
    v_exp_f32 v141, v141
    v_mfma_f32_32x32x16_bf16 v[176:191], v[112:115], v[240:243], v[176:191]
    v_cvt_pk_bf16_f32 v244, v136, v137
    v_exp_f32 v142, v142
    v_exp_f32 v143, v143
    v_cvt_pk_bf16_f32 v245, v138, v139
    v_cvt_pk_bf16_f32 v246, v140, v141
    v_cvt_pk_bf16_f32 v247, v142, v143
    v_exp_f32 v144, v144
    v_exp_f32 v145, v145
    v_mfma_f32_32x32x16_bf16 v[176:191], v[208:211], v[244:247], v[176:191]
    v_exp_f32 v146, v146
    v_exp_f32 v147, v147
    v_exp_f32 v148, v148
    v_exp_f32 v149, v149
    v_cvt_pk_bf16_f32 v240, v144, v145
    v_mfma_f32_32x32x16_bf16 v[128:143], v[88:91], v[248:251], v[224:239]
    v_exp_f32 v150, v150
    v_exp_f32 v151, v151
    v_cvt_pk_bf16_f32 v241, v146, v147
    v_exp_f32 v152, v152
    v_exp_f32 v153, v153
    v_cvt_pk_bf16_f32 v242, v148, v149
    v_exp_f32 v154, v154
    v_exp_f32 v155, v155
    v_cvt_pk_bf16_f32 v243, v150, v151
    ds_read_b64 v[168:169], v62
    ds_read_b128 v[160:163], v57
    ds_read_b128 v[164:167], v57 offset:1024
    v_exp_f32 v156, v156
    v_exp_f32 v157, v157
    v_mfma_f32_32x32x16_bf16 v[176:191], v[116:119], v[240:243], v[176:191]
    v_cvt_pk_bf16_f32 v244, v152, v153
    v_exp_f32 v158, v158
    v_exp_f32 v159, v159
    v_cvt_pk_bf16_f32 v245, v154, v155
    v_cvt_pk_bf16_f32 v246, v156, v157
    v_cvt_pk_bf16_f32 v247, v158, v159
    v_exp_f32 v128, v128
    v_exp_f32 v129, v129
    v_mfma_f32_32x32x16_bf16 v[176:191], v[212:215], v[244:247], v[176:191]
    v_exp_f32 v130, v130
    v_exp_f32 v131, v131
    v_exp_f32 v132, v132
    v_exp_f32 v133, v133
    v_cvt_pk_bf16_f32 v240, v128, v129
    v_mfma_f32_32x32x16_bf16 v[144:159], v[92:95], v[248:251], v[224:239]
    v_exp_f32 v134, v134
    v_exp_f32 v135, v135
    v_cvt_pk_bf16_f32 v241, v130, v131
    v_exp_f32 v136, v136
    v_exp_f32 v137, v137
    v_cvt_pk_bf16_f32 v242, v132, v133
    v_exp_f32 v138, v138
    v_exp_f32 v139, v139
    v_cvt_pk_bf16_f32 v243, v134, v135
    v_xor_b32 v252, 4096, v252
    ds_read_b128 v[248:251], v252
    v_exp_f32 v140, v140
    v_exp_f32 v141, v141
    v_mfma_f32_32x32x16_bf16 v[176:191], v[120:123], v[240:243], v[176:191]
    v_cvt_pk_bf16_f32 v244, v136, v137
    v_exp_f32 v142, v142
    v_exp_f32 v143, v143
    v_cvt_pk_bf16_f32 v245, v138, v139
    v_cvt_pk_bf16_f32 v246, v140, v141
    v_cvt_pk_bf16_f32 v247, v142, v143
    s_waitcnt lgkmcnt(0)
    v_cmp_ne_u32 vcc, 3, v169
    s_cmp_eq_u32 s13, 0
    s_cbranch_scc0 L_fbc_4
L_fbr_4:
    s_cbranch_vccnz L_retry_3
L_ok_3:
    s_setprio 2
    v_exp_f32 v144, v144
    v_exp_f32 v145, v145
    v_mfma_f32_32x32x16_bf16 v[176:191], v[216:219], v[244:247], v[176:191]
    v_exp_f32 v146, v146
    v_exp_f32 v147, v147
    v_exp_f32 v148, v148
    v_exp_f32 v149, v149
    v_cvt_pk_bf16_f32 v240, v144, v145
    v_mfma_f32_32x32x16_bf16 v[128:143], v[64:67], v[248:251], v[224:239]
    v_exp_f32 v150, v150
    v_exp_f32 v151, v151
    v_cvt_pk_bf16_f32 v241, v146, v147
    v_exp_f32 v152, v152
    v_exp_f32 v153, v153
    v_cvt_pk_bf16_f32 v242, v148, v149
    v_exp_f32 v154, v154
    v_exp_f32 v155, v155
    v_cvt_pk_bf16_f32 v243, v150, v151
    v_exp_f32 v156, v156
    v_exp_f32 v157, v157
    v_mfma_f32_32x32x16_bf16 v[176:191], v[124:127], v[240:243], v[176:191]
    v_cvt_pk_bf16_f32 v244, v152, v153
    v_exp_f32 v158, v158
    v_exp_f32 v159, v159
    v_cvt_pk_bf16_f32 v245, v154, v155
    v_cvt_pk_bf16_f32 v246, v156, v157
    v_cvt_pk_bf16_f32 v247, v158, v159
    v_exp_f32 v128, v128
    v_exp_f32 v129, v129
    v_mfma_f32_32x32x16_bf16 v[176:191], v[220:223], v[244:247], v[176:191]
    v_exp_f32 v130, v130
    v_exp_f32 v131, v131
    v_exp_f32 v132, v132
    v_exp_f32 v133, v133
    v_cvt_pk_bf16_f32 v240, v128, v129
    v_mfma_f32_32x32x16_bf16 v[144:159], v[68:71], v[248:251], v[224:239]
    v_exp_f32 v134, v134
    v_exp_f32 v135, v135
    v_cvt_pk_bf16_f32 v241, v130, v131
    v_exp_f32 v136, v136
    v_exp_f32 v137, v137
    v_cvt_pk_bf16_f32 v242, v132, v133
    v_exp_f32 v138, v138
    v_exp_f32 v139, v139
    v_cvt_pk_bf16_f32 v243, v134, v135
    v_exp_f32 v140, v140
    v_exp_f32 v141, v141
    v_mfma_f32_32x32x16_bf16 v[160:175], v[96:99], v[240:243], v[160:175]
    v_cvt_pk_bf16_f32 v244, v136, v137
    v_exp_f32 v142, v142
    v_exp_f32 v143, v143
    v_cvt_pk_bf16_f32 v245, v138, v139
    v_cvt_pk_bf16_f32 v246, v140, v141
    v_cvt_pk_bf16_f32 v247, v142, v143
    v_mov_b32 v185, 4
    ds_write_b128 v57, v[176:179]
    ds_write_b128 v57, v[180:183] offset:1024
    ds_write_b64 v62, v[184:185]
    s_bitcmp1_b32 s71, 8
    s_cbranch_scc1 L_hook8
L_hret8:
    v_exp_f32 v144, v144
    v_exp_f32 v145, v145
    v_mfma_f32_32x32x16_bf16 v[160:175], v[192:195], v[244:247], v[160:175]
    v_exp_f32 v146, v146
    v_exp_f32 v147, v147
    v_exp_f32 v148, v148
    v_exp_f32 v149, v149
    v_cvt_pk_bf16_f32 v240, v144, v145
    v_mfma_f32_32x32x16_bf16 v[128:143], v[72:75], v[248:251], v[224:239]
    v_exp_f32 v150, v150
    v_exp_f32 v151, v151
    v_cvt_pk_bf16_f32 v241, v146, v147
    v_exp_f32 v152, v152
    v_exp_f32 v153, v153
    v_cvt_pk_bf16_f32 v242, v148, v149
    v_exp_f32 v154, v154
    v_exp_f32 v155, v155
    v_cvt_pk_bf16_f32 v243, v150, v151
    v_exp_f32 v156, v156
    v_exp_f32 v157, v157
    v_mfma_f32_32x32x16_bf16 v[160:175], v[100:103], v[240:243], v[160:175]
    v_cvt_pk_bf16_f32 v244, v152, v153
    v_exp_f32 v158, v158
    v_exp_f32 v159, v159
    v_cvt_pk_bf16_f32 v245, v154, v155
    v_cvt_pk_bf16_f32 v246, v156, v157
    v_cvt_pk_bf16_f32 v247, v158, v159
    v_exp_f32 v128, v128
    v_exp_f32 v129, v129
    v_mfma_f32_32x32x16_bf16 v[160:175], v[196:199], v[244:247], v[160:175]
    v_exp_f32 v130, v130
    v_exp_f32 v131, v131
    v_exp_f32 v132, v132
    v_exp_f32 v133, v133
    v_cvt_pk_bf16_f32 v240, v128, v129
    v_mfma_f32_32x32x16_bf16 v[144:159], v[76:79], v[248:251], v[224:239]
    v_exp_f32 v134, v134
    v_exp_f32 v135, v135
    v_cvt_pk_bf16_f32 v241, v130, v131
    v_exp_f32 v136, v136
    v_exp_f32 v137, v137
    v_cvt_pk_bf16_f32 v242, v132, v133
    v_exp_f32 v138, v138
    v_exp_f32 v139, v139
    v_cvt_pk_bf16_f32 v243, v134, v135
    v_exp_f32 v140, v140
    v_exp_f32 v141, v141
    v_mfma_f32_32x32x16_bf16 v[160:175], v[104:107], v[240:243], v[160:175]
    v_cvt_pk_bf16_f32 v244, v136, v137
    v_exp_f32 v142, v142
    v_exp_f32 v143, v143
    v_cvt_pk_bf16_f32 v245, v138, v139
    v_cvt_pk_bf16_f32 v246, v140, v141
    v_cvt_pk_bf16_f32 v247, v142, v143
    v_exp_f32 v144, v144
    v_exp_f32 v145, v145
    v_mfma_f32_32x32x16_bf16 v[160:175], v[200:203], v[244:247], v[160:175]
    v_exp_f32 v146, v146
    v_exp_f32 v147, v147
    v_exp_f32 v148, v148
    v_exp_f32 v149, v149
    v_cvt_pk_bf16_f32 v240, v144, v145
    v_mfma_f32_32x32x16_bf16 v[128:143], v[80:83], v[248:251], v[224:239]
    v_exp_f32 v150, v150
    v_exp_f32 v151, v151
    v_cvt_pk_bf16_f32 v241, v146, v147
    v_exp_f32 v152, v152
    v_exp_f32 v153, v153
    v_cvt_pk_bf16_f32 v242, v148, v149
    v_exp_f32 v154, v154
    v_exp_f32 v155, v155
    v_cvt_pk_bf16_f32 v243, v150, v151
    v_exp_f32 v156, v156
    v_exp_f32 v157, v157
    v_mfma_f32_32x32x16_bf16 v[160:175], v[108:111], v[240:243], v[160:175]
    v_cvt_pk_bf16_f32 v244, v152, v153
    v_exp_f32 v158, v158
    v_exp_f32 v159, v159
    v_cvt_pk_bf16_f32 v245, v154, v155
    v_cvt_pk_bf16_f32 v246, v156, v157
    v_cvt_pk_bf16_f32 v247, v158, v159
    v_exp_f32 v128, v128
    v_exp_f32 v129, v129
    v_mfma_f32_32x32x16_bf16 v[160:175], v[204:207], v[244:247], v[160:175]
    v_exp_f32 v130, v130
    v_exp_f32 v131, v131
    v_exp_f32 v132, v132
    v_exp_f32 v133, v133
    v_cvt_pk_bf16_f32 v240, v128, v129
    v_mfma_f32_32x32x16_bf16 v[144:159], v[84:87], v[248:251], v[224:239]
    v_exp_f32 v134, v134
    v_exp_f32 v135, v135
    v_cvt_pk_bf16_f32 v241, v130, v131
    v_exp_f32 v136, v136
    v_exp_f32 v137, v137
    v_cvt_pk_bf16_f32 v242, v132, v133
    v_exp_f32 v138, v138
    v_exp_f32 v139, v139
    v_cvt_pk_bf16_f32 v243, v134, v135
    v_exp_f32 v140, v140
    v_exp_f32 v141, v141
    v_mfma_f32_32x32x16_bf16 v[160:175], v[112:115], v[240:243], v[160:175]
    v_cvt_pk_bf16_f32 v244, v136, v137
    v_exp_f32 v142, v142
    v_exp_f32 v143, v143
    v_cvt_pk_bf16_f32 v245, v138, v139
    v_cvt_pk_bf16_f32 v246, v140, v141
    v_cvt_pk_bf16_f32 v247, v142, v143
    v_exp_f32 v144, v144
    v_exp_f32 v145, v145
    v_mfma_f32_32x32x16_bf16 v[160:175], v[208:211], v[244:247], v[160:175]
    v_exp_f32 v146, v146
    v_exp_f32 v147, v147
    v_exp_f32 v148, v148
    v_exp_f32 v149, v149
    v_cvt_pk_bf16_f32 v240, v144, v145
    v_mfma_f32_32x32x16_bf16 v[128:143], v[88:91], v[248:251], v[224:239]
    v_exp_f32 v150, v150
    v_exp_f32 v151, v151
    v_cvt_pk_bf16_f32 v241, v146, v147
    v_exp_f32 v152, v152
    v_exp_f32 v153, v153
    v_cvt_pk_bf16_f32 v242, v148, v149
    v_exp_f32 v154, v154
    v_exp_f32 v155, v155
    v_cvt_pk_bf16_f32 v243, v150, v151
    ds_read_b64 v[184:185], v59
    ds_read_b128 v[176:179], v54
    ds_read_b128 v[180:183], v54 offset:1024
    v_exp_f32 v156, v156
    v_exp_f32 v157, v157
    v_mfma_f32_32x32x16_bf16 v[160:175], v[116:119], v[240:243], v[160:175]
    v_cvt_pk_bf16_f32 v244, v152, v153
    v_exp_f32 v158, v158
    v_exp_f32 v159, v159
    v_cvt_pk_bf16_f32 v245, v154, v155
    v_cvt_pk_bf16_f32 v246, v156, v157
    v_cvt_pk_bf16_f32 v247, v158, v159
    v_exp_f32 v128, v128
    v_exp_f32 v129, v129
    v_mfma_f32_32x32x16_bf16 v[160:175], v[212:215], v[244:247], v[160:175]
    v_exp_f32 v130, v130
    v_exp_f32 v131, v131
    v_exp_f32 v132, v132
    v_exp_f32 v133, v133
    v_cvt_pk_bf16_f32 v240, v128, v129
    v_mfma_f32_32x32x16_bf16 v[144:159], v[92:95], v[248:251], v[224:239]
    v_exp_f32 v134, v134
    v_exp_f32 v135, v135
    v_cvt_pk_bf16_f32 v241, v130, v131
    v_exp_f32 v136, v136
    v_exp_f32 v137, v137
    v_cvt_pk_bf16_f32 v242, v132, v133
    v_exp_f32 v138, v138
    v_exp_f32 v139, v139
    v_cvt_pk_bf16_f32 v243, v134, v135
    v_xor_b32 v253, 4096, v253
    ds_read_b128 v[248:251], v253
    v_exp_f32 v140, v140
    v_exp_f32 v141, v141
    v_mfma_f32_32x32x16_bf16 v[160:175], v[120:123], v[240:243], v[160:175]
    v_cvt_pk_bf16_f32 v244, v136, v137
    v_exp_f32 v142, v142
    v_exp_f32 v143, v143
    v_cvt_pk_bf16_f32 v245, v138, v139
    v_cvt_pk_bf16_f32 v246, v140, v141
    v_cvt_pk_bf16_f32 v247, v142, v143
    s_waitcnt lgkmcnt(0)
    v_cmp_ne_u32 vcc, 4, v185
    s_cmp_eq_u32 s13, 0
    s_cbranch_scc0 L_fbc_5
L_fbr_5:
    s_cbranch_vccnz L_retry_4
L_ok_4:
    v_exp_f32 v144, v144
    v_exp_f32 v145, v145
    v_mfma_f32_32x32x16_bf16 v[160:175], v[216:219], v[244:247], v[160:175]
    v_exp_f32 v146, v146
    v_exp_f32 v147, v147
    v_exp_f32 v148, v148
    v_exp_f32 v149, v149
    v_cvt_pk_bf16_f32 v240, v144, v145
    v_mfma_f32_32x32x16_bf16 v[128:143], v[64:67], v[248:251], v[224:239]
    v_exp_f32 v150, v150
    v_exp_f32 v151, v151
    v_cvt_pk_bf16_f32 v241, v146, v147
    v_exp_f32 v152, v152
    v_exp_f32 v153, v153
    v_cvt_pk_bf16_f32 v242, v148, v149
    v_exp_f32 v154, v154
    v_exp_f32 v155, v155
    v_cvt_pk_bf16_f32 v243, v150, v151
    v_exp_f32 v156, v156
    v_exp_f32 v157, v157
    v_mfma_f32_32x32x16_bf16 v[160:175], v[124:127], v[240:243], v[160:175]
    v_cvt_pk_bf16_f32 v244, v152, v153
    v_exp_f32 v158, v158
    v_exp_f32 v159, v159
    v_cvt_pk_bf16_f32 v245, v154, v155
    v_cvt_pk_bf16_f32 v246, v156, v157
    v_cvt_pk_bf16_f32 v247, v158, v159
    v_exp_f32 v128, v128
    v_exp_f32 v129, v129
    v_mfma_f32_32x32x16_bf16 v[160:175], v[220:223], v[244:247], v[160:175]
    v_exp_f32 v130, v130
    v_exp_f32 v131, v131
    v_exp_f32 v132, v132
    v_exp_f32 v133, v133
    v_cvt_pk_bf16_f32 v240, v128, v129
    v_mfma_f32_32x32x16_bf16 v[144:159], v[68:71], v[248:251], v[224:239]
    v_exp_f32 v134, v134
    v_exp_f32 v135, v135
    v_cvt_pk_bf16_f32 v241, v130, v131
    v_exp_f32 v136, v136
    v_exp_f32 v137, v137
    v_cvt_pk_bf16_f32 v242, v132, v133
    v_exp_f32 v138, v138
    v_exp_f32 v139, v139
    v_cvt_pk_bf16_f32 v243, v134, v135
    v_exp_f32 v140, v140
    v_exp_f32 v141, v141
    v_mfma_f32_32x32x16_bf16 v[176:191], v[96:99], v[240:243], v[176:191]
    v_cvt_pk_bf16_f32 v244, v136, v137
    v_exp_f32 v142, v142
    v_exp_f32 v143, v143
    v_cvt_pk_bf16_f32 v245, v138, v139
    v_cvt_pk_bf16_f32 v246, v140, v141
    v_cvt_pk_bf16_f32 v247, v142, v143
    v_mov_b32 v169, 5
    ds_write_b128 v54, v[160:163]
    ds_write_b128 v54, v[164:167] offset:1024
    ds_write_b64 v59, v[168:169]
    s_bitcmp1_b32 s71, 10
    s_cbranch_scc1 L_hook10
L_hret10:
    v_exp_f32 v144, v144
    v_exp_f32 v145, v145
    v_mfma_f32_32x32x16_bf16 v[176:191], v[192:195], v[244:247], v[176:191]
    v_exp_f32 v146, v146
    v_exp_f32 v147, v147
    v_exp_f32 v148, v148
    v_exp_f32 v149, v149
    v_cvt_pk_bf16_f32 v240, v144, v145
    v_mfma_f32_32x32x16_bf16 v[128:143], v[72:75], v[248:251], v[224:239]
    v_exp_f32 v150, v150
    v_exp_f32 v151, v151
    v_cvt_pk_bf16_f32 v241, v146, v147
    v_exp_f32 v152, v152
    v_exp_f32 v153, v153
    v_cvt_pk_bf16_f32 v242, v148, v149
    v_exp_f32 v154, v154
    v_exp_f32 v155, v155
    v_cvt_pk_bf16_f32 v243, v150, v151
    v_exp_f32 v156, v156
    v_exp_f32 v157, v157
    v_mfma_f32_32x32x16_bf16 v[176:191], v[100:103], v[240:243], v[176:191]
    v_cvt_pk_bf16_f32 v244, v152, v153
    v_exp_f32 v158, v158
    v_exp_f32 v159, v159
    v_cvt_pk_bf16_f32 v245, v154, v155
    v_cvt_pk_bf16_f32 v246, v156, v157
    v_cvt_pk_bf16_f32 v247, v158, v159
    v_exp_f32 v128, v128
    v_exp_f32 v129, v129
    v_mfma_f32_32x32x16_bf16 v[176:191], v[196:199], v[244:247], v[176:191]
    v_exp_f32 v130, v130
    v_exp_f32 v131, v131
    v_exp_f32 v132, v132
    v_exp_f32 v133, v133
    v_cvt_pk_bf16_f32 v240, v128, v129
    v_mfma_f32_32x32x16_bf16 v[144:159], v[76:79], v[248:251], v[224:239]
    v_exp_f32 v134, v134
    v_exp_f32 v135, v135
    v_cvt_pk_bf16_f32 v241, v130, v131
    v_exp_f32 v136, v136
    v_exp_f32 v137, v137
    v_cvt_pk_bf16_f32 v242, v132, v133
    v_exp_f32 v138, v138
    v_exp_f32 v139, v139
    v_cvt_pk_bf16_f32 v243, v134, v135
    v_exp_f32 v140, v140
    v_exp_f32 v141, v141
    v_mfma_f32_32x32x16_bf16 v[176:191], v[104:107], v[240:243], v[176:191]
    v_cvt_pk_bf16_f32 v244, v136, v137
    v_exp_f32 v142, v142
    v_exp_f32 v143, v143
    v_cvt_pk_bf16_f32 v245, v138, v139
    v_cvt_pk_bf16_f32 v246, v140, v141
    v_cvt_pk_bf16_f32 v247, v142, v143
    v_exp_f32 v144, v144
    v_exp_f32 v145, v145
    v_mfma_f32_32x32x16_bf16 v[176:191], v[200:203], v[244:247], v[176:191]
    v_exp_f32 v146, v146
    v_exp_f32 v147, v147
    v_exp_f32 v148, v148
    v_exp_f32 v149, v149
    v_cvt_pk_bf16_f32 v240, v144, v145
    v_mfma_f32_32x32x16_bf16 v[128:143], v[80:83], v[248:251], v[224:239]
    v_exp_f32 v150, v150
    v_exp_f32 v151, v151
    v_cvt_pk_bf16_f32 v241, v146, v147
    v_exp_f32 v152, v152
    v_exp_f32 v153, v153
    v_cvt_pk_bf16_f32 v242, v148, v149
    v_exp_f32 v154, v154
    v_exp_f32 v155, v155
    v_cvt_pk_bf16_f32 v243, v150, v151
    v_exp_f32 v156, v156
    v_exp_f32 v157, v157
    v_mfma_f32_32x32x16_bf16 v[176:191], v[108:111], v[240:243], v[176:191]
    v_cvt_pk_bf16_f32 v244, v152, v153
    v_exp_f32 v158, v158
    v_exp_f32 v159, v159
    v_cvt_pk_bf16_f32 v245, v154, v155
    v_cvt_pk_bf16_f32 v246, v156, v157
    v_cvt_pk_bf16_f32 v247, v158, v159
    v_exp_f32 v128, v128
    v_exp_f32 v129, v129
    v_mfma_f32_32x32x16_bf16 v[176:191], v[204:207], v[244:247], v[176:191]
    v_exp_f32 v130, v130
    v_exp_f32 v131, v131
    v_exp_f32 v132, v132
    v_exp_f32 v133, v133
    v_cvt_pk_bf16_f32 v240, v128, v129
    v_mfma_f32_32x32x16_bf16 v[144:159], v[84:87], v[248:251], v[224:239]
    v_exp_f32 v134, v134
    v_exp_f32 v135, v135
    v_cvt_pk_bf16_f32 v241, v130, v131
    v_exp_f32 v136, v136
    v_exp_f32 v137, v137
    v_cvt_pk_bf16_f32 v242, v132, v133
    v_exp_f32 v138, v138
    v_exp_f32 v139, v139
    v_cvt_pk_bf16_f32 v243, v134, v135
    v_exp_f32 v140, v140
    v_exp_f32 v141, v141
    v_mfma_f32_32x32x16_bf16 v[176:191], v[112:115], v[240:243], v[176:191]
    v_cvt_pk_bf16_f32 v244, v136, v137
    v_exp_f32 v142, v142
    v_exp_f32 v143, v143
    v_cvt_pk_bf16_f32 v245, v138, v139
    v_cvt_pk_bf16_f32 v246, v140, v141
    v_cvt_pk_bf16_f32 v247, v142, v143
    s_bitcmp1_b32 s71, 11
    s_cbranch_scc1 L_hook11
L_hret11:
    v_exp_f32 v144, v144
    v_exp_f32 v145, v145
    v_mfma_f32_32x32x16_bf16 v[176:191], v[208:211], v[244:247], v[176:191]
    v_exp_f32 v146, v146
    v_exp_f32 v147, v147
    v_exp_f32 v148, v148
    v_exp_f32 v149, v149
    v_cvt_pk_bf16_f32 v240, v144, v145
    v_mfma_f32_32x32x16_bf16 v[128:143], v[88:91], v[248:251], v[224:239]
    v_exp_f32 v150, v150
    v_exp_f32 v151, v151
    v_cvt_pk_bf16_f32 v241, v146, v147
    v_exp_f32 v152, v152
    v_exp_f32 v153, v153
    v_cvt_pk_bf16_f32 v242, v148, v149
    v_exp_f32 v154, v154
    v_exp_f32 v155, v155
    v_cvt_pk_bf16_f32 v243, v150, v151
    ds_read_b64 v[168:169], v60
    ds_read_b128 v[160:163], v55
    ds_read_b128 v[164:167], v55 offset:1024
    v_exp_f32 v156, v156
    v_exp_f32 v157, v157
    v_mfma_f32_32x32x16_bf16 v[176:191], v[116:119], v[240:243], v[176:191]
    v_cvt_pk_bf16_f32 v244, v152, v153
    v_exp_f32 v158, v158
    v_exp_f32 v159, v159
    v_cvt_pk_bf16_f32 v245, v154, v155
    v_cvt_pk_bf16_f32 v246, v156, v157
    v_cvt_pk_bf16_f32 v247, v158, v159
    v_exp_f32 v128, v128
    v_exp_f32 v129, v129
    v_mfma_f32_32x32x16_bf16 v[176:191], v[212:215], v[244:247], v[176:191]
    v_exp_f32 v130, v130
    v_exp_f32 v131, v131
    v_exp_f32 v132, v132
    v_exp_f32 v133, v133
    v_cvt_pk_bf16_f32 v240, v128, v129
    v_mfma_f32_32x32x16_bf16 v[144:159], v[92:95], v[248:251], v[224:239]
    v_exp_f32 v134, v134
    v_exp_f32 v135, v135
    v_cvt_pk_bf16_f32 v241, v130, v131
    v_exp_f32 v136, v136
    v_exp_f32 v137, v137
    v_cvt_pk_bf16_f32 v242, v132, v133
    v_exp_f32 v138, v138
    v_exp_f32 v139, v139
    v_cvt_pk_bf16_f32 v243, v134, v135
    v_xor_b32 v254, 4096, v254
    ds_read_b128 v[248:251], v254
    v_exp_f32 v140, v140
    v_exp_f32 v141, v141
    v_mfma_f32_32x32x16_bf16 v[176:191], v[120:123], v[240:243], v[176:191]
    v_cvt_pk_bf16_f32 v244, v136, v137
    v_exp_f32 v142, v142
    v_exp_f32 v143, v143
    v_cvt_pk_bf16_f32 v245, v138, v139
    v_cvt_pk_bf16_f32 v246, v140, v141
    v_cvt_pk_bf16_f32 v247, v142, v143
    s_waitcnt lgkmcnt(0)
    v_cmp_ne_u32 vcc, 5, v169
    s_cmp_eq_u32 s13, 0
    s_cbranch_scc0 L_fbc_6
L_fbr_6:
    s_cbranch_vccnz L_retry_5
L_ok_5:
    s_setprio 1
    v_exp_f32 v144, v144
    v_exp_f32 v145, v145
    v_mfma_f32_32x32x16_bf16 v[176:191], v[216:219], v[244:247], v[176:191]
    v_exp_f32 v146, v146
    v_exp_f32 v147, v147
    v_exp_f32 v148, v148
    v_exp_f32 v149, v149
    v_cvt_pk_bf16_f32 v240, v144, v145
    v_mfma_f32_32x32x16_bf16 v[128:143], v[64:67], v[248:251], v[224:239]
    v_exp_f32 v150, v150
    v_exp_f32 v151, v151
    v_cvt_pk_bf16_f32 v241, v146, v147
    v_exp_f32 v152, v152
    v_exp_f32 v153, v153
    v_cvt_pk_bf16_f32 v242, v148, v149
    v_exp_f32 v154, v154
    v_exp_f32 v155, v155
    v_cvt_pk_bf16_f32 v243, v150, v151
    v_exp_f32 v156, v156
    v_exp_f32 v157, v157
    v_mfma_f32_32x32x16_bf16 v[176:191], v[124:127], v[240:243], v[176:191]
    v_cvt_pk_bf16_f32 v244, v152, v153
    v_exp_f32 v158, v158
    v_exp_f32 v159, v159
    v_cvt_pk_bf16_f32 v245, v154, v155
    v_cvt_pk_bf16_f32 v246, v156, v157
    v_cvt_pk_bf16_f32 v247, v158, v159
    v_exp_f32 v128, v128
    v_exp_f32 v129, v129
    v_mfma_f32_32x32x16_bf16 v[176:191], v[220:223], v[244:247], v[176:191]
    v_exp_f32 v130, v130
    v_exp_f32 v131, v131
    v_exp_f32 v132, v132
    v_exp_f32 v133, v133
    v_cvt_pk_bf16_f32 v240, v128, v129
    v_mfma_f32_32x32x16_bf16 v[144:159], v[68:71], v[248:251], v[224:239]
    v_exp_f32 v134, v134
    v_exp_f32 v135, v135
    v_cvt_pk_bf16_f32 v241, v130, v131
    v_exp_f32 v136, v136
    v_exp_f32 v137, v137
    v_cvt_pk_bf16_f32 v242, v132, v133
    v_exp_f32 v138, v138
    v_exp_f32 v139, v139
    v_cvt_pk_bf16_f32 v243, v134, v135
    v_exp_f32 v140, v140
    v_exp_f32 v141, v141
    v_mfma_f32_32x32x16_bf16 v[160:175], v[96:99], v[240:243], v[160:175]
    v_cvt_pk_bf16_f32 v244, v136, v137
    v_exp_f32 v142, v142
    v_exp_f32 v143, v143
    v_cvt_pk_bf16_f32 v245, v138, v139
    v_cvt_pk_bf16_f32 v246, v140, v141
    v_cvt_pk_bf16_f32 v247, v142, v143
    v_mov_b32 v185, 6
    ds_write_b128 v55, v[176:179]
    ds_write_b128 v55, v[180:183] offset:1024
    ds_write_b64 v60, v[184:185]
    s_bitcmp1_b32 s71, 12
    s_cbranch_scc1 L_hook12
L_hret12:
    v_exp_f32 v144, v144
    v_exp_f32 v145, v145
    v_mfma_f32_32x32x16_bf16 v[160:175], v[192:195], v[244:247], v[160:175]
    v_exp_f32 v146, v146
    v_exp_f32 v147, v147
    v_exp_f32 v148, v148
    v_exp_f32 v149, v149
    v_cvt_pk_bf16_f32 v240, v144, v145
    v_mfma_f32_32x32x16_bf16 v[128:143], v[72:75], v[248:251], v[224:239]
    v_exp_f32 v150, v150
    v_exp_f32 v151, v151
    v_cvt_pk_bf16_f32 v241, v146, v147
    v_exp_f32 v152, v152
    v_exp_f32 v153, v153
    v_cvt_pk_bf16_f32 v242, v148, v149
    v_exp_f32 v154, v154
    v_exp_f32 v155, v155
    v_cvt_pk_bf16_f32 v243, v150, v151
    v_exp_f32 v156, v156
    v_exp_f32 v157, v157
    v_mfma_f32_32x32x16_bf16 v[160:175], v[100:103], v[240:243], v[160:175]
    v_cvt_pk_bf16_f32 v244, v152, v153
    v_exp_f32 v158, v158
    v_exp_f32 v159, v159
    v_cvt_pk_bf16_f32 v245, v154, v155
    v_cvt_pk_bf16_f32 v246, v156, v157
    v_cvt_pk_bf16_f32 v247, v158, v159
    v_exp_f32 v128, v128
    v_exp_f32 v129, v129
    v_mfma_f32_32x32x16_bf16 v[160:175], v[196:199], v[244:247], v[160:175]
    v_exp_f32 v130, v130
    v_exp_f32 v131, v131
    v_exp_f32 v132, v132
    v_exp_f32 v133, v133
    v_cvt_pk_bf16_f32 v240, v128, v129
    v_mfma_f32_32x32x16_bf16 v[144:159], v[76:79], v[248:251], v[224:239]
    v_exp_f32 v134, v134
    v_exp_f32 v135, v135
    v_cvt_pk_bf16_f32 v241, v130, v131
    v_exp_f32 v136, v136
    v_exp_f32 v137, v137
    v_cvt_pk_bf16_f32 v242, v132, v133
    v_exp_f32 v138, v138
    v_exp_f32 v139, v139
    v_cvt_pk_bf16_f32 v243, v134, v135
    v_exp_f32 v140, v140
    v_exp_f32 v141, v141
    v_mfma_f32_32x32x16_bf16 v[160:175], v[104:107], v[240:243], v[160:175]
    v_cvt_pk_bf16_f32 v244, v136, v137
    v_exp_f32 v142, v142
    v_exp_f32 v143, v143
    v_cvt_pk_bf16_f32 v245, v138, v139
    v_cvt_pk_bf16_f32 v246, v140, v141
    v_cvt_pk_bf16_f32 v247, v142, v143
    v_exp_f32 v144, v144
    v_exp_f32 v145, v145
    v_mfma_f32_32x32x16_bf16 v[160:175], v[200:203], v[244:247], v[160:175]
    v_exp_f32 v146, v146
    v_exp_f32 v147, v147
    v_exp_f32 v148, v148
    v_exp_f32 v149, v149
    v_cvt_pk_bf16_f32 v240, v144, v145
    v_mfma_f32_32x32x16_bf16 v[128:143], v[80:83], v[248:251], v[224:239]
    v_exp_f32 v150, v150
    v_exp_f32 v151, v151
    v_cvt_pk_bf16_f32 v241, v146, v147
    v_exp_f32 v152, v152
    v_exp_f32 v153, v153
    v_cvt_pk_bf16_f32 v242, v148, v149
    v_exp_f32 v154, v154
    v_exp_f32 v155, v155
    v_cvt_pk_bf16_f32 v243, v150, v151
    v_exp_f32 v156, v156
    v_exp_f32 v157, v157
    v_mfma_f32_32x32x16_bf16 v[160:175], v[108:111], v[240:243], v[160:175]
    v_cvt_pk_bf16_f32 v244, v152, v153
    v_exp_f32 v158, v158
    v_exp_f32 v159, v159
    v_cvt_pk_bf16_f32 v245, v154, v155
    v_cvt_pk_bf16_f32 v246, v156, v157
    v_cvt_pk_bf16_f32 v247, v158, v159
    v_exp_f32 v128, v128
    v_exp_f32 v129, v129
    v_mfma_f32_32x32x16_bf16 v[160:175], v[204:207], v[244:247], v[160:175]
    v_exp_f32 v130, v130
    v_exp_f32 v131, v131
    v_exp_f32 v132, v132
    v_exp_f32 v133, v133
    v_cvt_pk_bf16_f32 v240, v128, v129
    v_mfma_f32_32x32x16_bf16 v[144:159], v[84:87], v[248:251], v[224:239]
    v_exp_f32 v134, v134
    v_exp_f32 v135, v135
    v_cvt_pk_bf16_f32 v241, v130, v131
    v_exp_f32 v136, v136
    v_exp_f32 v137, v137
    v_cvt_pk_bf16_f32 v242, v132, v133
    v_exp_f32 v138, v138
    v_exp_f32 v139, v139
    v_cvt_pk_bf16_f32 v243, v134, v135
    v_exp_f32 v140, v140
    v_exp_f32 v141, v141
    v_mfma_f32_32x32x16_bf16 v[160:175], v[112:115], v[240:243], v[160:175]
    v_cvt_pk_bf16_f32 v244, v136, v137
    v_exp_f32 v142, v142
    v_exp_f32 v143, v143
    v_cvt_pk_bf16_f32 v245, v138, v139
    v_cvt_pk_bf16_f32 v246, v140, v141
    v_cvt_pk_bf16_f32 v247, v142, v143
    v_exp_f32 v144, v144
    v_exp_f32 v145, v145
    v_mfma_f32_32x32x16_bf16 v[160:175], v[208:211], v[244:247], v[160:175]
    v_exp_f32 v146, v146
    v_exp_f32 v147, v147
    v_exp_f32 v148, v148
    v_exp_f32 v149, v149
    v_cvt_pk_bf16_f32 v240, v144, v145
    v_mfma_f32_32x32x16_bf16 v[128:143], v[88:91], v[248:251], v[224:239]
    v_exp_f32 v150, v150
    v_exp_f32 v151, v151
    v_cvt_pk_bf16_f32 v241, v146, v147
    v_exp_f32 v152, v152
    v_exp_f32 v153, v153
    v_cvt_pk_bf16_f32 v242, v148, v149
    v_exp_f32 v154, v154
    v_exp_f32 v155, v155
    v_cvt_pk_bf16_f32 v243, v150, v151
    ds_read_b64 v[184:185], v61
    ds_read_b128 v[176:179], v56
    ds_read_b128 v[180:183], v56 offset:1024
    v_exp_f32 v156, v156
    v_exp_f32 v157, v157
    v_mfma_f32_32x32x16_bf16 v[160:175], v[116:119], v[240:243], v[160:175]
    v_cvt_pk_bf16_f32 v244, v152, v153
    v_exp_f32 v158, v158
    v_exp_f32 v159, v159
    v_cvt_pk_bf16_f32 v245, v154, v155
    v_cvt_pk_bf16_f32 v246, v156, v157
    v_cvt_pk_bf16_f32 v247, v158, v159
    v_exp_f32 v128, v128
    v_exp_f32 v129, v129
    v_mfma_f32_32x32x16_bf16 v[160:175], v[212:215], v[244:247], v[160:175]
    v_exp_f32 v130, v130
    v_exp_f32 v131, v131
    v_exp_f32 v132, v132
    v_exp_f32 v133, v133
    v_cvt_pk_bf16_f32 v240, v128, v129
    v_mfma_f32_32x32x16_bf16 v[144:159], v[92:95], v[248:251], v[224:239]
    v_exp_f32 v134, v134
    v_exp_f32 v135, v135
    v_cvt_pk_bf16_f32 v241, v130, v131
    v_exp_f32 v136, v136
    v_exp_f32 v137, v137
    v_cvt_pk_bf16_f32 v242, v132, v133
    v_exp_f32 v138, v138
    v_exp_f32 v139, v139
    v_cvt_pk_bf16_f32 v243, v134, v135
    v_xor_b32 v255, 4096, v255
    ds_read_b128 v[248:251], v255
    v_exp_f32 v140, v140
    v_exp_f32 v141, v141
    v_mfma_f32_32x32x16_bf16 v[160:175], v[120:123], v[240:243], v[160:175]
    v_cvt_pk_bf16_f32 v244, v136, v137
    v_exp_f32 v142, v142
    v_exp_f32 v143, v143
    v_cvt_pk_bf16_f32 v245, v138, v139
    v_cvt_pk_bf16_f32 v246, v140, v141
    v_cvt_pk_bf16_f32 v247, v142, v143
    s_waitcnt lgkmcnt(0)
    v_cmp_ne_u32 vcc, 6, v185
    s_cmp_eq_u32 s13, 0
    s_cbranch_scc0 L_fbc_7
L_fbr_7:
    s_cbranch_vccnz L_retry_6
L_ok_6:
    s_setprio 0
    v_exp_f32 v144, v144
    v_exp_f32 v145, v145
    v_mfma_f32_32x32x16_bf16 v[160:175], v[216:219], v[244:247], v[160:175]
    v_exp_f32 v146, v146
    v_exp_f32 v147, v147
    v_exp_f32 v148, v148
    v_exp_f32 v149, v149
    v_cvt_pk_bf16_f32 v240, v144, v145
    v_mfma_f32_32x32x16_bf16 v[128:143], v[64:67], v[248:251], v[224:239]
    v_exp_f32 v150, v150
    v_exp_f32 v151, v151
    v_cvt_pk_bf16_f32 v241, v146, v147
    v_exp_f32 v152, v152
    v_exp_f32 v153, v153
    v_cvt_pk_bf16_f32 v242, v148, v149
    v_exp_f32 v154, v154
    v_exp_f32 v155, v155
    v_cvt_pk_bf16_f32 v243, v150, v151
    v_exp_f32 v156, v156
    v_exp_f32 v157, v157
    v_mfma_f32_32x32x16_bf16 v[160:175], v[124:127], v[240:243], v[160:175]
    v_cvt_pk_bf16_f32 v244, v152, v153
    v_exp_f32 v158, v158
    v_exp_f32 v159, v159
    v_cvt_pk_bf16_f32 v245, v154, v155
    v_cvt_pk_bf16_f32 v246, v156, v157
    v_cvt_pk_bf16_f32 v247, v158, v159
    v_exp_f32 v128, v128
    v_exp_f32 v129, v129
    v_mfma_f32_32x32x16_bf16 v[160:175], v[220:223], v[244:247], v[160:175]
    v_exp_f32 v130, v130
    v_exp_f32 v131, v131
    v_exp_f32 v132, v132
    v_exp_f32 v133, v133
    v_cvt_pk_bf16_f32 v240, v128, v129
    v_mfma_f32_32x32x16_bf16 v[144:159], v[68:71], v[248:251], v[224:239]
    v_exp_f32 v134, v134
    v_exp_f32 v135, v135
    v_cvt_pk_bf16_f32 v241, v130, v131
    v_exp_f32 v136, v136
    v_exp_f32 v137, v137
    v_cvt_pk_bf16_f32 v242, v132, v133
    v_exp_f32 v138, v138
    v_exp_f32 v139, v139
    v_cvt_pk_bf16_f32 v243, v134, v135
    v_exp_f32 v140, v140
    v_exp_f32 v141, v141
    v_mfma_f32_32x32x16_bf16 v[176:191], v[96:99], v[240:243], v[176:191]
    v_cvt_pk_bf16_f32 v244, v136, v137
    v_exp_f32 v142, v142
    v_exp_f32 v143, v143
    v_cvt_pk_bf16_f32 v245, v138, v139
    v_cvt_pk_bf16_f32 v246, v140, v141
    v_cvt_pk_bf16_f32 v247, v142, v143
    v_mov_b32 v169, 7
    ds_write_b128 v56, v[160:163]
    ds_write_b128 v56, v[164:167] offset:1024
    ds_write_b64 v61, v[168:169]
    s_bitcmp1_b32 s71, 14
    s_cbranch_scc1 L_hook14
L_hret14:
    v_exp_f32 v144, v144
    v_exp_f32 v145, v145
    v_mfma_f32_32x32x16_bf16 v[176:191], v[192:195], v[244:247], v[176:191]
    v_exp_f32 v146, v146
    v_exp_f32 v147, v147
    v_exp_f32 v148, v148
    v_exp_f32 v149, v149
    v_cvt_pk_bf16_f32 v240, v144, v145
    v_mfma_f32_32x32x16_bf16 v[128:143], v[72:75], v[248:251], v[224:239]
    v_exp_f32 v150, v150
    v_exp_f32 v151, v151
    v_cvt_pk_bf16_f32 v241, v146, v147
    v_exp_f32 v152, v152
    v_exp_f32 v153, v153
    v_cvt_pk_bf16_f32 v242, v148, v149
    v_exp_f32 v154, v154
    v_exp_f32 v155, v155
    v_cvt_pk_bf16_f32 v243, v150, v151
    v_exp_f32 v156, v156
    v_exp_f32 v157, v157
    v_mfma_f32_32x32x16_bf16 v[176:191], v[100:103], v[240:243], v[176:191]
    v_cvt_pk_bf16_f32 v244, v152, v153
    v_exp_f32 v158, v158
    v_exp_f32 v159, v159
    v_cvt_pk_bf16_f32 v245, v154, v155
    v_cvt_pk_bf16_f32 v246, v156, v157
    v_cvt_pk_bf16_f32 v247, v158, v159
    v_exp_f32 v128, v128
    v_exp_f32 v129, v129
    v_mfma_f32_32x32x16_bf16 v[176:191], v[196:199], v[244:247], v[176:191]
    v_exp_f32 v130, v130
    v_exp_f32 v131, v131
    v_exp_f32 v132, v132
    v_exp_f32 v133, v133
    v_cvt_pk_bf16_f32 v240, v128, v129
    v_mfma_f32_32x32x16_bf16 v[144:159], v[76:79], v[248:251], v[224:239]
    v_exp_f32 v134, v134
    v_exp_f32 v135, v135
    v_cvt_pk_bf16_f32 v241, v130, v131
    v_exp_f32 v136, v136
    v_exp_f32 v137, v137
    v_cvt_pk_bf16_f32 v242, v132, v133
    v_exp_f32 v138, v138
    v_exp_f32 v139, v139
    v_cvt_pk_bf16_f32 v243, v134, v135
    v_exp_f32 v140, v140
    v_exp_f32 v141, v141
    v_mfma_f32_32x32x16_bf16 v[176:191], v[104:107], v[240:243], v[176:191]
    v_cvt_pk_bf16_f32 v244, v136, v137
    v_exp_f32 v142, v142
    v_exp_f32 v143, v143
    v_cvt_pk_bf16_f32 v245, v138, v139
    v_cvt_pk_bf16_f32 v246, v140, v141
    v_cvt_pk_bf16_f32 v247, v142, v143
    v_exp_f32 v144, v144
    v_exp_f32 v145, v145
    v_mfma_f32_32x32x16_bf16 v[176:191], v[200:203], v[244:247], v[176:191]
    v_exp_f32 v146, v146
    v_exp_f32 v147, v147
    v_exp_f32 v148, v148
    v_exp_f32 v149, v149
    v_cvt_pk_bf16_f32 v240, v144, v145
    v_mfma_f32_32x32x16_bf16 v[128:143], v[80:83], v[248:251], v[224:239]
    v_exp_f32 v150, v150
    v_exp_f32 v151, v151
    v_cvt_pk_bf16_f32 v241, v146, v147
    v_exp_f32 v152, v152
    v_exp_f32 v153, v153
    v_cvt_pk_bf16_f32 v242, v148, v149
    v_exp_f32 v154, v154
    v_exp_f32 v155, v155
    v_cvt_pk_bf16_f32 v243, v150, v151
    v_exp_f32 v156, v156
    v_exp_f32 v157, v157
    v_mfma_f32_32x32x16_bf16 v[176:191], v[108:111], v[240:243], v[176:191]
    v_cvt_pk_bf16_f32 v244, v152, v153
    v_exp_f32 v158, v158
    v_exp_f32 v159, v159
    v_cvt_pk_bf16_f32 v245, v154, v155
    v_cvt_pk_bf16_f32 v246, v156, v157
    v_cvt_pk_bf16_f32 v247, v158, v159
    v_exp_f32 v128, v128
    v_exp_f32 v129, v129
    v_mfma_f32_32x32x16_bf16 v[176:191], v[204:207], v[244:247], v[176:191]
    v_exp_f32 v130, v130
    v_exp_f32 v131, v131
    v_exp_f32 v132, v132
    v_exp_f32 v133, v133
    v_cvt_pk_bf16_f32 v240, v128, v129
    v_mfma_f32_32x32x16_bf16 v[144:159], v[84:87], v[248:251], v[224:239]
    v_exp_f32 v134, v134
    v_exp_f32 v135, v135
    v_cvt_pk_bf16_f32 v241, v130, v131
    v_exp_f32 v136, v136
    v_exp_f32 v137, v137
    v_cvt_pk_bf16_f32 v242, v132, v133
    v_exp_f32 v138, v138
    v_exp_f32 v139, v139
    v_cvt_pk_bf16_f32 v243, v134, v135
    v_exp_f32 v140, v140
    v_exp_f32 v141, v141
    v_mfma_f32_32x32x16_bf16 v[176:191], v[112:115], v[240:243], v[176:191]
    v_cvt_pk_bf16_f32 v244, v136, v137
    v_exp_f32 v142, v142
    v_exp_f32 v143, v143
    v_cvt_pk_bf16_f32 v245, v138, v139
    v_cvt_pk_bf16_f32 v246, v140, v141
    v_cvt_pk_bf16_f32 v247, v142, v143
    v_exp_f32 v144, v144
    v_exp_f32 v145, v145
    v_mfma_f32_32x32x16_bf16 v[176:191], v[208:211], v[244:247], v[176:191]
    v_exp_f32 v146, v146
    v_exp_f32 v147, v147
    v_exp_f32 v148, v148
    v_exp_f32 v149, v149
    v_cvt_pk_bf16_f32 v240, v144, v145
    v_mfma_f32_32x32x16_bf16 v[128:143], v[88:91], v[248:251], v[224:239]
    v_exp_f32 v150, v150
    v_exp_f32 v151, v151
    v_cvt_pk_bf16_f32 v241, v146, v147
    v_exp_f32 v152, v152
    v_exp_f32 v153, v153
    v_cvt_pk_bf16_f32 v242, v148, v149
    v_exp_f32 v154, v154
    v_exp_f32 v155, v155
    v_cvt_pk_bf16_f32 v243, v150, v151
    v_exp_f32 v156, v156
    v_exp_f32 v157, v157
    v_mfma_f32_32x32x16_bf16 v[176:191], v[116:119], v[240:243], v[176:191]
    v_cvt_pk_bf16_f32 v244, v152, v153
    v_exp_f32 v158, v158
    v_exp_f32 v159, v159
    v_cvt_pk_bf16_f32 v245, v154, v155
    v_cvt_pk_bf16_f32 v246, v156, v157
    v_cvt_pk_bf16_f32 v247, v158, v159
    v_exp_f32 v128, v128
    v_exp_f32 v129, v129
    v_mfma_f32_32x32x16_bf16 v[176:191], v[212:215], v[244:247], v[176:191]
    v_exp_f32 v130, v130
    v_exp_f32 v131, v131
    v_exp_f32 v132, v132
    v_exp_f32 v133, v133
    v_cvt_pk_bf16_f32 v240, v128, v129
    v_mfma_f32_32x32x16_bf16 v[144:159], v[92:95], v[248:251], v[224:239]
    v_exp_f32 v134, v134
    v_exp_f32 v135, v135
    v_cvt_pk_bf16_f32 v241, v130, v131
    v_exp_f32 v136, v136
    v_exp_f32 v137, v137
    v_cvt_pk_bf16_f32 v242, v132, v133
    v_exp_f32 v138, v138
    v_exp_f32 v139, v139
    v_cvt_pk_bf16_f32 v243, v134, v135
    ds_read_b64 v[168:169], v63
    ds_read_b128 v[160:163], v58
    ds_read_b128 v[164:167], v58 offset:1024
    ds_read_b32 v53, v52
    v_exp_f32 v140, v140
    v_exp_f32 v141, v141
    v_mfma_f32_32x32x16_bf16 v[176:191], v[120:123], v[240:243], v[176:191]
    v_cvt_pk_bf16_f32 v244, v136, v137
    v_exp_f32 v142, v142
    v_exp_f32 v143, v143
    v_cvt_pk_bf16_f32 v245, v138, v139
    v_cvt_pk_bf16_f32 v246, v140, v141
    v_cvt_pk_bf16_f32 v247, v142, v143
    v_exp_f32 v144, v144
    v_exp_f32 v145, v145
    v_mfma_f32_32x32x16_bf16 v[176:191], v[216:219], v[244:247], v[176:191]
    v_exp_f32 v146, v146
    v_exp_f32 v147, v147
    v_exp_f32 v148, v148
    v_exp_f32 v149, v149
    v_cvt_pk_bf16_f32 v240, v144, v145
    v_exp_f32 v150, v150
    v_exp_f32 v151, v151
    v_cvt_pk_bf16_f32 v241, v146, v147
    v_exp_f32 v152, v152
    v_exp_f32 v153, v153
    v_cvt_pk_bf16_f32 v242, v148, v149
    v_exp_f32 v154, v154
    v_exp_f32 v155, v155
    v_cvt_pk_bf16_f32 v243, v150, v151
    v_exp_f32 v156, v156
    v_exp_f32 v157, v157
    v_mfma_f32_32x32x16_bf16 v[176:191], v[124:127], v[240:243], v[176:191]
    v_cvt_pk_bf16_f32 v244, v152, v153
    v_exp_f32 v158, v158
    v_exp_f32 v159, v159
    v_cvt_pk_bf16_f32 v245, v154, v155
    v_cvt_pk_bf16_f32 v246, v156, v157
    v_cvt_pk_bf16_f32 v247, v158, v159
    v_mov_b32 v50, 161808
    s_cmp_ge_u32 s3, 4
    v_mfma_f32_32x32x16_bf16 v[176:191], v[220:223], v[244:247], v[176:191]
    s_setprio 3
    s_cbranch_scc1 L_tfin
    s_and_b32 s8, s3, 1
    s_lshr_b32 s9, s3, 1
    s_lshl_b32 s18, s8, 1
    s_add_u32 s18, s18, s9
    s_lshl_b32 s11, s82, 15
    s_add_u32 s6, s11, 1048576
    s_lshr_b32 s7, s5, 1
    s_lshl_b32 s7, s7, 8
    s_add_u32 s11, s11, s7
    s_lshl_b32 s7, s18, 6
    s_add_u32 s11, s11, s7
    v_and_b32 v228, 31, v1
    v_lshrrev_b32 v229, 5, v1
    v_lshlrev_b32 v230, 10, v228
    v_lshl_add_u32 v231, v229, 4, v230
    v_lshl_add_u32 v230, v229, 3, v230
    buffer_load_dwordx2 v[40:41], v230, s[44:47], s11 offen offset:0
    buffer_load_dwordx2 v[42:43], v230, s[44:47], s11 offen offset:16
    buffer_load_dwordx2 v[44:45], v230, s[44:47], s11 offen offset:32
    buffer_load_dwordx2 v[46:47], v230, s[44:47], s11 offen offset:48
    s_lshl_b32 s9, s9, 1
    s_sub_u32 s10, 3, s9
    s_lshl_b32 s7, s10, 10
    s_add_u32 s19, s6, s7
    s_lshl_b32 s7, s9, 10
    s_add_u32 s20, s6, s7
    s_lshl_b32 s7, s80, 2
    s_add_u32 s8, s7, s10
    s_lshl_b32 s21, 1, s8
    s_add_u32 s8, s7, s9
    s_lshl_b32 s22, 1, s8
    s_or_b32 s22, s22, 0xaa
    s_xor_b32 s8, s3, 2
    s_lshl_b32 s23, 0x100, s8
    s_lshl_b32 s24, 0x100, s3
    v_lshrrev_b32 v226, 2, v2
    v_and_b32 v227, 3, v2
    v_and_b32 v224, 1, v3
    s_lshl_b32 s7, s18, 1
    v_or_b32 v224, s7, v224
    v_lshlrev_b32 v225, 1, v226
    v_xor_b32 v224, v224, v225
    v_lshlrev_b32 v224, 5, v224
    v_lshl_add_u32 v224, v227, 3, v224
    v_lshl_add_u32 v225, v229, 2, v226
    v_lshl_add_u32 v224, v225, 8, v224
    s_lshl_b32 s7, s10, 12
    v_add_u32 v224, s7, v224
    v_xor_b32 v225, 64, v224
    v_add_u32 v226, 0x10000, v224
    v_add_u32 v227, 0x10000, v225
    v_lshlrev_b32 v230, 2, v228
    s_lshl_b32 s7, s3, 13
    s_add_u32 s7, s7, 4096
    v_add_u32 v233, s7, v5
    v_xor_b32 v234, 0x4000, v233
    v_mov_b32 v235, s24
L_gow:
    ds_read_b32 v51, v52
    s_waitcnt lgkmcnt(0)
    v_readfirstlane_b32 s8, v51
    s_nop 0
    s_and_b32 s8, s8, 7
    s_cmp_eq_u32 s8, 5
    s_cbranch_scc0 L_gow
    s_lshl_b32 s7, s82, 7
    s_add_u32 s7, s7, 393216
    buffer_load_dword v48, v230, s[60:63], s7 offen sc1
    ds_read_b64_tr_b16 v[64:65], v224 offset:0
    ds_read_b64_tr_b16 v[66:67], v224 offset:2048
    ds_read_b64_tr_b16 v[68:69], v225 offset:0
    ds_read_b64_tr_b16 v[70:71], v225 offset:2048
    ds_read_b64_tr_b16 v[72:73], v224 offset:16384
    ds_read_b64_tr_b16 v[74:75], v224 offset:18432
    ds_read_b64_tr_b16 v[76:77], v225 offset:16384
    ds_read_b64_tr_b16 v[78:79], v225 offset:18432
    ds_read_b64_tr_b16 v[80:81], v224 offset:32768
    ds_read_b64_tr_b16 v[82:83], v224 offset:34816
    ds_read_b64_tr_b16 v[84:85], v225 offset:32768
    ds_read_b64_tr_b16 v[86:87], v225 offset:34816
    ds_read_b64_tr_b16 v[88:89], v224 offset:49152
    ds_read_b64_tr_b16 v[90:91], v224 offset:51200
    ds_read_b64_tr_b16 v[92:93], v225 offset:49152
    ds_read_b64_tr_b16 v[94:95], v225 offset:51200
    ds_read_b64_tr_b16 v[96:97], v226 offset:0
    ds_read_b64_tr_b16 v[98:99], v226 offset:2048
    ds_read_b64_tr_b16 v[100:101], v227 offset:0
    ds_read_b64_tr_b16 v[102:103], v227 offset:2048
    ds_read_b64_tr_b16 v[104:105], v226 offset:16384
    ds_read_b64_tr_b16 v[106:107], v226 offset:18432
    ds_read_b64_tr_b16 v[108:109], v227 offset:16384
    ds_read_b64_tr_b16 v[110:111], v227 offset:18432
    ds_read_b64_tr_b16 v[112:113], v226 offset:32768
    ds_read_b64_tr_b16 v[114:115], v226 offset:34816
    ds_read_b64_tr_b16 v[116:117], v227 offset:32768
    ds_read_b64_tr_b16 v[118:119], v227 offset:34816
    ds_read_b64_tr_b16 v[120:121], v226 offset:49152
    ds_read_b64_tr_b16 v[122:123], v226 offset:51200
    ds_read_b64_tr_b16 v[124:125], v227 offset:49152
    ds_read_b64_tr_b16 v[126:127], v227 offset:51200
    s_mov_b32 s79, 0
    s_sub_u32 s7, s20, s19
    s_lshl_b32 s7, s7, 2
    v_add_u32 v224, s7, v224
    v_add_u32 v225, s7, v225
    v_add_u32 v226, s7, v226
    v_add_u32 v227, s7, v227
    s_branch L_retry_7b
L_tfin:
    s_waitcnt lgkmcnt(0)
    v_mul_u32_u24 v169, v53, v169
    v_cmp_ne_u32 vcc, 35, v169
    s_nop 4
    s_cbranch_vccnz L_retry_7
L_ok_7:
    v_readfirstlane_b32 s9, v53
    v_mov_b32 v7, s27
    v_add_f32 v184, v184, v168
    v_add_f32 v176, v176, v160
    v_add_f32 v177, v177, v161
    v_add_f32 v178, v178, v162
    v_add_f32 v179, v179, v163
    v_rcp_f32 v51, v184
    v_add_f32 v180, v180, v164
    v_add_f32 v181, v181, v165
    v_add_f32 v182, v182, v166
    v_add_f32 v183, v183, v167
    v_cmp_gt_f32 vcc, 0x17800000, v184
    v_mul_f32 v176, v176, v51
    v_mul_f32 v177, v177, v51
    v_mul_f32 v178, v178, v51
    v_mul_f32 v179, v179, v51
    v_mul_f32 v180, v180, v51
    v_mul_f32 v181, v181, v51
    v_mul_f32 v182, v182, v51
    v_mul_f32 v183, v183, v51
    v_cvt_pk_bf16_f32 v240, v176, v177
    v_cvt_pk_bf16_f32 v241, v178, v179
    v_cvt_pk_bf16_f32 v242, v180, v181
    v_cvt_pk_bf16_f32 v243, v182, v183
    s_cmp_eq_u32 s9, 5
    v_min_u32 v240, -2, v240
    v_min_u32 v241, -2, v241
    v_min_u32 v242, -2, v242
    v_min_u32 v243, -2, v243
    s_cbranch_vccnz L_bad
    s_cbranch_scc1 L_pubx
    buffer_store_dwordx4 v[240:243], v5, s[60:63], s26 offen
L_nopub:
    s_mov_b64 exec, 1
    ds_add_u32 v50, v7
    s_mov_b64 exec, -1
    s_cmp_ge_u32 s3, 4
    s_cbranch_scc1 L_tbar
L_pw_4:
    ds_read_b32 v51, v50
    s_waitcnt lgkmcnt(0)
    v_readfirstlane_b32 s8, v51
    s_nop 0
    s_and_b32 s8, s8, s21
    s_cmp_eq_u32 s8, s21
    s_cbranch_scc0 L_pw_4
    s_add_u32 s7, s19, 0
    buffer_load_dwordx4 v[128:131], v5, s[60:63], s7 offen sc1
    s_add_u32 s7, s19, 4096
    buffer_load_dwordx4 v[132:135], v5, s[60:63], s7 offen sc1
    s_add_u32 s7, s19, 8192
    buffer_load_dwordx4 v[136:139], v5, s[60:63], s7 offen sc1
    s_add_u32 s7, s19, 12288
    buffer_load_dwordx4 v[140:143], v5, s[60:63], s7 offen sc1
    s_add_u32 s7, s19, 16384
    buffer_load_dwordx4 v[144:147], v5, s[60:63], s7 offen sc1
    s_add_u32 s7, s19, 20480
    buffer_load_dwordx4 v[148:151], v5, s[60:63], s7 offen sc1
    s_add_u32 s7, s19, 24576
    buffer_load_dwordx4 v[152:155], v5, s[60:63], s7 offen sc1
    s_add_u32 s7, s19, 28672
    buffer_load_dwordx4 v[156:159], v5, s[60:63], s7 offen sc1
L_oc10:
    s_waitcnt vmcnt(6)
    v_max3_u32 v232, v128, v129, v130
    v_max3_u32 v232, v232, v131, v132
    v_max3_u32 v232, v232, v133, v134
    v_max_u32 v232, v232, v135
    v_cmp_eq_u32 vcc, -1, v232
    s_nop 0
    s_cbranch_vccnz L_or10
L_og10:
    v_mfma_f32_32x32x16_bf16 v[208:223], v[68:71], v[128:131], 0
    v_mfma_f32_32x32x16_bf16 v[192:207], v[64:67], v[128:131], 0
    ds_read_b64_tr_b16 v[64:65], v224 offset:0
    ds_read_b64_tr_b16 v[66:67], v224 offset:2048
    ds_read_b64_tr_b16 v[68:69], v225 offset:0
    ds_read_b64_tr_b16 v[70:71], v225 offset:2048
    v_mfma_f32_32x32x16_bf16 v[208:223], v[76:79], v[132:135], v[208:223]
    v_mfma_f32_32x32x16_bf16 v[192:207], v[72:75], v[132:135], v[192:207]
    ds_read_b64_tr_b16 v[72:73], v224 offset:16384
    ds_read_b64_tr_b16 v[74:75], v224 offset:18432
    ds_read_b64_tr_b16 v[76:77], v225 offset:16384
    ds_read_b64_tr_b16 v[78:79], v225 offset:18432
L_oc11:
    s_waitcnt vmcnt(4)
    v_max3_u32 v232, v136, v137, v138
    v_max3_u32 v232, v232, v139, v140
    v_max3_u32 v232, v232, v141, v142
    v_max_u32 v232, v232, v143
    v_cmp_eq_u32 vcc, -1, v232
    s_nop 0
    s_cbranch_vccnz L_or11
L_og11:
    v_mfma_f32_32x32x16_bf16 v[208:223], v[84:87], v[136:139], v[208:223]
    v_mfma_f32_32x32x16_bf16 v[192:207], v[80:83], v[136:139], v[192:207]
    ds_read_b64_tr_b16 v[80:81], v224 offset:32768
    ds_read_b64_tr_b16 v[82:83], v224 offset:34816
    ds_read_b64_tr_b16 v[84:85], v225 offset:32768
    ds_read_b64_tr_b16 v[86:87], v225 offset:34816
    v_mfma_f32_32x32x16_bf16 v[208:223], v[92:95], v[140:143], v[208:223]
    v_mfma_f32_32x32x16_bf16 v[192:207], v[88:91], v[140:143], v[192:207]
    ds_read_b64_tr_b16 v[88:89], v224 offset:49152
    ds_read_b64_tr_b16 v[90:91], v224 offset:51200
    ds_read_b64_tr_b16 v[92:93], v225 offset:49152
    ds_read_b64_tr_b16 v[94:95], v225 offset:51200
L_oc12:
    s_waitcnt vmcnt(2)
    v_max3_u32 v232, v144, v145, v146
    v_max3_u32 v232, v232, v147, v148
    v_max3_u32 v232, v232, v149, v150
    v_max_u32 v232, v232, v151
    v_cmp_eq_u32 vcc, -1, v232
    s_nop 0
    s_cbranch_vccnz L_or12
L_og12:
    v_mfma_f32_32x32x16_bf16 v[208:223], v[100:103], v[144:147], v[208:223]
    v_mfma_f32_32x32x16_bf16 v[192:207], v[96:99], v[144:147], v[192:207]
    ds_read_b64_tr_b16 v[96:97], v226 offset:0
    ds_read_b64_tr_b16 v[98:99], v226 offset:2048
    ds_read_b64_tr_b16 v[100:101], v227 offset:0
    ds_read_b64_tr_b16 v[102:103], v227 offset:2048
    v_mfma_f32_32x32x16_bf16 v[208:223], v[108:111], v[148:151], v[208:223]
    v_mfma_f32_32x32x16_bf16 v[192:207], v[104:107], v[148:151], v[192:207]
    ds_read_b64_tr_b16 v[104:105], v226 offset:16384
    ds_read_b64_tr_b16 v[106:107], v226 offset:18432
    ds_read_b64_tr_b16 v[108:109], v227 offset:16384
    ds_read_b64_tr_b16 v[110:111], v227 offset:18432
L_oc13:
    s_waitcnt vmcnt(0)
    v_max3_u32 v232, v152, v153, v154
    v_max3_u32 v232, v232, v155, v156
    v_max3_u32 v232, v232, v157, v158
    v_max_u32 v232, v232, v159
    v_cmp_eq_u32 vcc, -1, v232
    s_nop 0
    s_cbranch_vccnz L_or13
L_og13:
    v_mfma_f32_32x32x16_bf16 v[208:223], v[116:119], v[152:155], v[208:223]
    v_mfma_f32_32x32x16_bf16 v[192:207], v[112:115], v[152:155], v[192:207]
    ds_read_b64_tr_b16 v[112:113], v226 offset:32768
    ds_read_b64_tr_b16 v[114:115], v226 offset:34816
    ds_read_b64_tr_b16 v[116:117], v227 offset:32768
    ds_read_b64_tr_b16 v[118:119], v227 offset:34816
    v_mfma_f32_32x32x16_bf16 v[208:223], v[124:127], v[156:159], v[208:223]
    v_mfma_f32_32x32x16_bf16 v[192:207], v[120:123], v[156:159], v[192:207]
    ds_read_b64_tr_b16 v[120:121], v226 offset:49152
    ds_read_b64_tr_b16 v[122:123], v226 offset:51200
    ds_read_b64_tr_b16 v[124:125], v227 offset:49152
    ds_read_b64_tr_b16 v[126:127], v227 offset:51200
L_pw_5:
    ds_read_b32 v51, v50
    s_waitcnt lgkmcnt(0)
    v_readfirstlane_b32 s8, v51
    s_nop 0
    s_and_b32 s8, s8, s22
    s_cmp_eq_u32 s8, s22
    s_cbranch_scc0 L_pw_5
    s_add_u32 s7, s20, 0
    buffer_load_dwordx4 v[128:131], v5, s[60:63], s7 offen sc1
    s_add_u32 s7, s20, 4096
    buffer_load_dwordx4 v[132:135], v5, s[60:63], s7 offen sc1
    s_add_u32 s7, s20, 8192
    buffer_load_dwordx4 v[136:139], v5, s[60:63], s7 offen sc1
    s_add_u32 s7, s20, 12288
    buffer_load_dwordx4 v[140:143], v5, s[60:63], s7 offen sc1
    s_add_u32 s7, s20, 16384
    buffer_load_dwordx4 v[144:147], v5, s[60:63], s7 offen sc1
    s_add_u32 s7, s20, 20480
    buffer_load_dwordx4 v[148:151], v5, s[60:63], s7 offen sc1
    s_add_u32 s7, s20, 24576
    buffer_load_dwordx4 v[152:155], v5, s[60:63], s7 offen sc1
    s_add_u32 s7, s20, 28672
    buffer_load_dwordx4 v[156:159], v5, s[60:63], s7 offen sc1
    v_sub_f32 v49, 1.0, v48
    v_lshlrev_b32 v24, 16, v40
    v_and_b32 v25, 0xffff0000, v40
    v_lshlrev_b32 v26, 16, v41
    v_and_b32 v27, 0xffff0000, v41
    v_lshlrev_b32 v28, 16, v42
    v_and_b32 v29, 0xffff0000, v42
    v_lshlrev_b32 v30, 16, v43
    v_and_b32 v31, 0xffff0000, v43
    v_lshlrev_b32 v32, 16, v44
    v_and_b32 v33, 0xffff0000, v44
    v_lshlrev_b32 v34, 16, v45
    v_and_b32 v35, 0xffff0000, v45
    v_lshlrev_b32 v36, 16, v46
    v_and_b32 v37, 0xffff0000, v46
    v_lshlrev_b32 v38, 16, v47
    v_and_b32 v39, 0xffff0000, v47
    s_cmp_eq_u32 s78, 1
    s_cbranch_scc1 L_y
L_noy:
    v_mul_f32 v24, v24, v49
    v_mul_f32 v25, v25, v49
    v_mul_f32 v26, v26, v49
    v_mul_f32 v27, v27, v49
    v_mul_f32 v28, v28, v49
    v_mul_f32 v29, v29, v49
    v_mul_f32 v30, v30, v49
    v_mul_f32 v31, v31, v49
    v_mul_f32 v32, v32, v49
    v_mul_f32 v33, v33, v49
    v_mul_f32 v34, v34, v49
    v_mul_f32 v35, v35, v49
    v_mul_f32 v36, v36, v49
    v_mul_f32 v37, v37, v49
    v_mul_f32 v38, v38, v49
    v_mul_f32 v39, v39, v49
L_oc00:
    s_waitcnt vmcnt(6)
    v_max3_u32 v232, v128, v129, v130
    v_max3_u32 v232, v232, v131, v132
    v_max3_u32 v232, v232, v133, v134
    v_max_u32 v232, v232, v135
    v_cmp_eq_u32 vcc, -1, v232
    s_nop 0
    s_cbranch_vccnz L_or00
L_og00:
    v_mfma_f32_32x32x16_bf16 v[208:223], v[68:71], v[128:131], v[208:223]
    v_mfma_f32_32x32x16_bf16 v[192:207], v[64:67], v[128:131], v[192:207]
    v_mfma_f32_32x32x16_bf16 v[208:223], v[76:79], v[132:135], v[208:223]
    v_mfma_f32_32x32x16_bf16 v[192:207], v[72:75], v[132:135], v[192:207]
L_oc01:
    s_waitcnt vmcnt(4)
    v_max3_u32 v232, v136, v137, v138
    v_max3_u32 v232, v232, v139, v140
    v_max3_u32 v232, v232, v141, v142
    v_max_u32 v232, v232, v143
    v_cmp_eq_u32 vcc, -1, v232
    s_nop 0
    s_cbranch_vccnz L_or01
L_og01:
    v_mfma_f32_32x32x16_bf16 v[208:223], v[84:87], v[136:139], v[208:223]
    v_mfma_f32_32x32x16_bf16 v[192:207], v[80:83], v[136:139], v[192:207]
    v_mfma_f32_32x32x16_bf16 v[208:223], v[92:95], v[140:143], v[208:223]
    v_mfma_f32_32x32x16_bf16 v[192:207], v[88:91], v[140:143], v[192:207]
L_oc02:
    s_waitcnt vmcnt(2)
    v_max3_u32 v232, v144, v145, v146
    v_max3_u32 v232, v232, v147, v148
    v_max3_u32 v232, v232, v149, v150
    v_max_u32 v232, v232, v151
    v_cmp_eq_u32 vcc, -1, v232
    s_nop 0
    s_cbranch_vccnz L_or02
L_og02:
    v_mfma_f32_32x32x16_bf16 v[208:223], v[100:103], v[144:147], v[208:223]
    v_mfma_f32_32x32x16_bf16 v[192:207], v[96:99], v[144:147], v[192:207]
    v_mfma_f32_32x32x16_bf16 v[208:223], v[108:111], v[148:151], v[208:223]
    v_mfma_f32_32x32x16_bf16 v[192:207], v[104:107], v[148:151], v[192:207]
L_oc03:
    s_waitcnt vmcnt(0)
    v_max3_u32 v232, v152, v153, v154
    v_max3_u32 v232, v232, v155, v156
    v_max3_u32 v232, v232, v157, v158
    v_max_u32 v232, v232, v159
    v_cmp_eq_u32 vcc, -1, v232
    s_nop 0
    s_cbranch_vccnz L_or03
L_og03:
    v_mfma_f32_32x32x16_bf16 v[208:223], v[116:119], v[152:155], v[208:223]
    v_mfma_f32_32x32x16_bf16 v[208:223], v[124:127], v[156:159], v[208:223]
    v_mfma_f32_32x32x16_bf16 v[192:207], v[112:115], v[152:155], v[192:207]
    v_mfma_f32_32x32x16_bf16 v[192:207], v[120:123], v[156:159], v[192:207]
    s_nop 9
    ds_write_b128 v233, v[208:211] offset:0
    ds_write_b128 v233, v[212:215] offset:1024
    ds_write_b128 v233, v[216:219] offset:2048
    ds_write_b128 v233, v[220:223] offset:3072
    s_mov_b64 exec, 1
    ds_add_u32 v50, v235
    s_mov_b64 exec, -1
    v_fmac_f32 v24, v192, v48
    v_fmac_f32 v25, v193, v48
    v_fmac_f32 v26, v194, v48
    v_fmac_f32 v27, v195, v48
    v_fmac_f32 v28, v196, v48
    v_fmac_f32 v29, v197, v48
    v_fmac_f32 v30, v198, v48
    v_fmac_f32 v31, v199, v48
    v_fmac_f32 v32, v200, v48
    v_fmac_f32 v33, v201, v48
    v_fmac_f32 v34, v202, v48
    v_fmac_f32 v35, v203, v48
    v_fmac_f32 v36, v204, v48
    v_fmac_f32 v37, v205, v48
    v_fmac_f32 v38, v206, v48
    v_fmac_f32 v39, v207, v48
L_xw:
    ds_read_b32 v51, v50
    ds_read_b128 v[128:131], v234 offset:0
    ds_read_b128 v[132:135], v234 offset:1024
    ds_read_b128 v[136:139], v234 offset:2048
    ds_read_b128 v[140:143], v234 offset:3072
    s_waitcnt lgkmcnt(4)
    v_readfirstlane_b32 s8, v51
    s_nop 0
    s_and_b32 s7, s8, s23
    s_cbranch_scc0 L_xr
    s_waitcnt lgkmcnt(0)
    v_fmac_f32 v24, v128, v48
    v_fmac_f32 v25, v129, v48
    v_fmac_f32 v26, v130, v48
    v_fmac_f32 v27, v131, v48
    v_fmac_f32 v28, v132, v48
    v_fmac_f32 v29, v133, v48
    v_fmac_f32 v30, v134, v48
    v_fmac_f32 v31, v135, v48
    v_fmac_f32 v32, v136, v48
    v_fmac_f32 v33, v137, v48
    v_fmac_f32 v34, v138, v48
    v_fmac_f32 v35, v139, v48
    v_fmac_f32 v36, v140, v48
    v_fmac_f32 v37, v141, v48
    v_fmac_f32 v38, v142, v48
    v_fmac_f32 v39, v143, v48
    v_cvt_pk_bf16_f32 v240, v24, v25
    v_cvt_pk_bf16_f32 v241, v26, v27
    v_cvt_pk_bf16_f32 v242, v28, v29
    v_cvt_pk_bf16_f32 v243, v30, v31
    v_cvt_pk_bf16_f32 v244, v32, v33
    v_cvt_pk_bf16_f32 v245, v34, v35
    v_cvt_pk_bf16_f32 v246, v36, v37
    v_cvt_pk_bf16_f32 v247, v38, v39
    v_permlane32_swap_b32 v240, v242
    v_permlane32_swap_b32 v241, v243
    v_permlane32_swap_b32 v244, v246
    v_permlane32_swap_b32 v245, v247
    buffer_store_dwordx4 v[240:243], v231, s[64:67], s11 offen offset:0
    buffer_store_dwordx4 v[244:247], v231, s[64:67], s11 offen offset:32
    s_or_b32 s6, s2, s3
    s_cbranch_scc1 L_nobump
    v_mov_b32 v6, 0
    v_mov_b32 v7, s68
    s_mov_b32 s6, 327680
    buffer_store_dword v7, v6, s[60:63], s6 offen
L_nobump:
L_tbar:
    s_waitcnt lgkmcnt(0)
    s_barrier
    ds_read_b32 v51, v50
    s_waitcnt lgkmcnt(0)
    v_readfirstlane_b32 s8, v51
    s_nop 0
    s_cmp_ge_u32 s8, 0x10000
    s_cbranch_scc1 L_fallback
L_end:
    s_endpgm
L_retry_1:
    s_sleep 1
    s_add_u32 s12, s12, 1
    s_cmp_gt_u32 s12, 4194304
    s_cbranch_scc1 L_ok_1
    ds_read_b64 v[168:169], v60
    ds_read_b128 v[160:163], v55
    ds_read_b128 v[164:167], v55 offset:1024
    s_waitcnt lgkmcnt(0)
    v_cmp_ne_u32 vcc, 1, v169
    s_nop 4
    s_cbranch_vccnz L_retry_1
    s_branch L_ok_1
L_retry_2:
    s_sleep 1
    s_add_u32 s12, s12, 1
    s_cmp_gt_u32 s12, 4194304
    s_cbranch_scc1 L_ok_2
    ds_read_b64 v[184:185], v61
    ds_read_b128 v[176:179], v56
    ds_read_b128 v[180:183], v56 offset:1024
    s_waitcnt lgkmcnt(0)
    v_cmp_ne_u32 vcc, 2, v185
    s_nop 4
    s_cbranch_vccnz L_retry_2
    s_branch L_ok_2
L_retry_3:
    s_sleep 1
    s_add_u32 s12, s12, 1
    s_cmp_gt_u32 s12, 4194304
    s_cbranch_scc1 L_ok_3
    ds_read_b64 v[168:169], v62
    ds_read_b128 v[160:163], v57
    ds_read_b128 v[164:167], v57 offset:1024
    s_waitcnt lgkmcnt(0)
    v_cmp_ne_u32 vcc, 3, v169
    s_nop 4
    s_cbranch_vccnz L_retry_3
    s_branch L_ok_3
L_retry_4:
    s_sleep 1
    s_add_u32 s12, s12, 1
    s_cmp_gt_u32 s12, 4194304
    s_cbranch_scc1 L_ok_4
    ds_read_b64 v[184:185], v59
    ds_read_b128 v[176:179], v54
    ds_read_b128 v[180:183], v54 offset:1024
    s_waitcnt lgkmcnt(0)
    v_cmp_ne_u32 vcc, 4, v185
    s_nop 4
    s_cbranch_vccnz L_retry_4
    s_branch L_ok_4
L_retry_5:
    s_sleep 1
    s_add_u32 s12, s12, 1
    s_cmp_gt_u32 s12, 4194304
    s_cbranch_scc1 L_ok_5
    ds_read_b64 v[168:169], v60
    ds_read_b128 v[160:163], v55
    ds_read_b128 v[164:167], v55 offset:1024
    s_waitcnt lgkmcnt(0)
    v_cmp_ne_u32 vcc, 5, v169
    s_nop 4
    s_cbranch_vccnz L_retry_5
    s_branch L_ok_5
L_retry_6:
    s_sleep 1
    s_add_u32 s12, s12, 1
    s_cmp_gt_u32 s12, 4194304
    s_cbranch_scc1 L_ok_6
    ds_read_b64 v[184:185], v61
    ds_read_b128 v[176:179], v56
    ds_read_b128 v[180:183], v56 offset:1024
    s_waitcnt lgkmcnt(0)
    v_cmp_ne_u32 vcc, 6, v185
    s_nop 4
    s_cbranch_vccnz L_retry_6
    s_branch L_ok_6
L_retry_7:
    s_sleep 1
    s_add_u32 s12, s12, 1
    s_cmp_gt_u32 s12, 4194304
    s_cbranch_scc1 L_ok_7
L_retry_7b:
    ds_read_b64 v[168:169], v63
    ds_read_b128 v[160:163], v58
    ds_read_b128 v[164:167], v58 offset:1024
    ds_read_b32 v53, v52
    s_waitcnt lgkmcnt(0)
    v_mul_u32_u24 v169, v53, v169
    v_cmp_ne_u32 vcc, 35, v169
    s_nop 4
    s_cbranch_vccnz L_retry_7
    s_branch L_ok_7
L_pubx:
    buffer_store_dwordx4 v[240:243], v5, s[60:63], s26 offen sc1
    s_branch L_nopub
L_bad:
    s_cmp_eq_u32 s13, 0
    s_cbranch_scc0 L_pubx
    v_add_u32 v7, 0x10000, v7
    s_branch L_nopub
L_xr:
    s_cmp_ge_u32 s8, 0x10000
    s_cbranch_scc1 L_tbar
    s_branch L_xw
L_y:
    v_add_f32_dpp v12, v8, v8 row_ror:8 row_mask:0xf bank_mask:0xf
    v_add_f32_dpp v13, v9, v9 row_ror:8 row_mask:0xf bank_mask:0xf
    v_add_f32_dpp v14, v10, v10 row_ror:8 row_mask:0xf bank_mask:0xf
    v_add_f32_dpp v15, v11, v11 row_ror:8 row_mask:0xf bank_mask:0xf
    v_mov_b32 v16, v12
    v_mov_b32 v17, v13
    v_mov_b32 v18, v14
    v_mov_b32 v19, v15
    v_permlane32_swap_b32 v12, v16
    v_permlane32_swap_b32 v13, v17
    v_permlane32_swap_b32 v14, v18
    v_permlane32_swap_b32 v15, v19
    v_add_f32 v12, v12, v16
    v_add_f32 v13, v13, v17
    v_add_f32 v14, v14, v18
    v_add_f32 v15, v15, v19
    v_mov_b32 v16, v12
    v_mov_b32 v17, v13
    v_mov_b32 v18, v14
    v_mov_b32 v19, v15
    v_permlane16_swap_b32 v12, v16
    v_permlane16_swap_b32 v13, v17
    v_permlane16_swap_b32 v14, v18
    v_permlane16_swap_b32 v15, v19
    v_add_f32 v12, v12, v16
    v_add_f32 v13, v13, v17
    v_add_f32 v14, v14, v18
    v_add_f32 v15, v15, v19
    v_mov_b32 v16, s15
    v_ashrrev_i32 v17, 31, v16
    v_not_b32 v17, v17
    v_or_b32 v17, 0x80000000, v17
    v_xor_b32 v16, v16, v17
    v_and_b32 v16, 0xffff0000, v16
    v_mul_f32 v16, 0xbfb8aa3b, v16
    v_exp_f32 v16, v16
    s_nop 0
    v_add_f32 v16, 1.0, v16
    v_rcp_f32 v16, v16
    s_nop 0
    v_cvt_pk_bf16_f32 v16, v16, v16
    v_and_b32 v16, 0xffff0000, v16
    v_cvt_pk_bf16_f32 v12, v12, v12
    v_and_b32 v12, 0xffff0000, v12
    v_mul_f32 v12, v12, v16
    v_cvt_pk_bf16_f32 v12, v12, v12
    v_and_b32 v12, 0xffff0000, v12
    v_cvt_pk_bf16_f32 v13, v13, v13
    v_and_b32 v13, 0xffff0000, v13
    v_mul_f32 v13, v13, v16
    v_cvt_pk_bf16_f32 v13, v13, v13
    v_and_b32 v13, 0xffff0000, v13
    v_cvt_pk_bf16_f32 v14, v14, v14
    v_and_b32 v14, 0xffff0000, v14
    v_mul_f32 v14, v14, v16
    v_cvt_pk_bf16_f32 v14, v14, v14
    v_and_b32 v14, 0xffff0000, v14
    v_cvt_pk_bf16_f32 v15, v15, v15
    v_and_b32 v15, 0xffff0000, v15
    v_mul_f32 v15, v15, v16
    v_cvt_pk_bf16_f32 v15, v15, v15
    v_and_b32 v15, 0xffff0000, v15
    s_lshl_b32 s7, s3, 7
    s_add_u32 s7, s7, 162304
    v_add_u32 v17, s7, v5
    s_mov_b64 exec, 0xff
    ds_write_b128 v17, v[12:15]
    s_mov_b64 exec, -1
    v_lshl_add_u32 v17, v229, 4, s7
    ds_read_b128 v[160:163], v17 offset:0
    ds_read_b128 v[164:167], v17 offset:32
    ds_read_b128 v[168:171], v17 offset:64
    ds_read_b128 v[172:175], v17 offset:96
    s_and_b32 s8, s14, 31
    v_cmp_eq_u32 vcc, s8, v228
    s_waitcnt lgkmcnt(0)
    s_mov_b64 exec, vcc
    v_add_f32 v24, v24, v160
    v_add_f32 v25, v25, v161
    v_add_f32 v26, v26, v162
    v_add_f32 v27, v27, v163
    v_add_f32 v28, v28, v164
    v_add_f32 v29, v29, v165
    v_add_f32 v30, v30, v166
    v_add_f32 v31, v31, v167
    v_add_f32 v32, v32, v168
    v_add_f32 v33, v33, v169
    v_add_f32 v34, v34, v170
    v_add_f32 v35, v35, v171
    v_add_f32 v36, v36, v172
    v_add_f32 v37, v37, v173
    v_add_f32 v38, v38, v174
    v_add_f32 v39, v39, v175
    s_mov_b64 exec, -1
    s_branch L_noy
L_or10:
    s_add_u32 s79, s79, 1
    s_cmp_gt_u32 s79, 262144
    s_cbranch_scc1 L_og10
    ds_read_b32 v51, v50
    s_add_u32 s7, s19, 0
    buffer_load_dwordx4 v[128:131], v5, s[60:63], s7 offen sc1
    s_add_u32 s7, s19, 4096
    buffer_load_dwordx4 v[132:135], v5, s[60:63], s7 offen sc1
    s_add_u32 s7, s19, 8192
    buffer_load_dwordx4 v[136:139], v5, s[60:63], s7 offen sc1
    s_add_u32 s7, s19, 12288
    buffer_load_dwordx4 v[140:143], v5, s[60:63], s7 offen sc1
    s_add_u32 s7, s19, 16384
    buffer_load_dwordx4 v[144:147], v5, s[60:63], s7 offen sc1
    s_add_u32 s7, s19, 20480
    buffer_load_dwordx4 v[148:151], v5, s[60:63], s7 offen sc1
    s_add_u32 s7, s19, 24576
    buffer_load_dwordx4 v[152:155], v5, s[60:63], s7 offen sc1
    s_add_u32 s7, s19, 28672
    buffer_load_dwordx4 v[156:159], v5, s[60:63], s7 offen sc1
    s_waitcnt lgkmcnt(0)
    v_readfirstlane_b32 s8, v51
    s_nop 0
    s_cmp_ge_u32 s8, 0x10000
    s_cbranch_scc1 L_tbar
    s_branch L_oc10
L_or11:
    s_add_u32 s79, s79, 1
    s_cmp_gt_u32 s79, 262144
    s_cbranch_scc1 L_og11
    ds_read_b32 v51, v50
    s_add_u32 s7, s19, 8192
    buffer_load_dwordx4 v[136:139], v5, s[60:63], s7 offen sc1
    s_add_u32 s7, s19, 12288
    buffer_load_dwordx4 v[140:143], v5, s[60:63], s7 offen sc1
    s_add_u32 s7, s19, 16384
    buffer_load_dwordx4 v[144:147], v5, s[60:63], s7 offen sc1
    s_add_u32 s7, s19, 20480
    buffer_load_dwordx4 v[148:151], v5, s[60:63], s7 offen sc1
    s_add_u32 s7, s19, 24576
    buffer_load_dwordx4 v[152:155], v5, s[60:63], s7 offen sc1
    s_add_u32 s7, s19, 28672
    buffer_load_dwordx4 v[156:159], v5, s[60:63], s7 offen sc1
    s_waitcnt lgkmcnt(0)
    v_readfirstlane_b32 s8, v51
    s_nop 0
    s_cmp_ge_u32 s8, 0x10000
    s_cbranch_scc1 L_tbar
    s_branch L_oc11
L_or12:
    s_add_u32 s79, s79, 1
    s_cmp_gt_u32 s79, 262144
    s_cbranch_scc1 L_og12
    ds_read_b32 v51, v50
    s_add_u32 s7, s19, 16384
    buffer_load_dwordx4 v[144:147], v5, s[60:63], s7 offen sc1
    s_add_u32 s7, s19, 20480
    buffer_load_dwordx4 v[148:151], v5, s[60:63], s7 offen sc1
    s_add_u32 s7, s19, 24576
    buffer_load_dwordx4 v[152:155], v5, s[60:63], s7 offen sc1
    s_add_u32 s7, s19, 28672
    buffer_load_dwordx4 v[156:159], v5, s[60:63], s7 offen sc1
    s_waitcnt lgkmcnt(0)
    v_readfirstlane_b32 s8, v51
    s_nop 0
    s_cmp_ge_u32 s8, 0x10000
    s_cbranch_scc1 L_tbar
    s_branch L_oc12
L_or13:
    s_add_u32 s79, s79, 1
    s_cmp_gt_u32 s79, 262144
    s_cbranch_scc1 L_og13
    ds_read_b32 v51, v50
    s_add_u32 s7, s19, 24576
    buffer_load_dwordx4 v[152:155], v5, s[60:63], s7 offen sc1
    s_add_u32 s7, s19, 28672
    buffer_load_dwordx4 v[156:159], v5, s[60:63], s7 offen sc1
    s_waitcnt lgkmcnt(0)
    v_readfirstlane_b32 s8, v51
    s_nop 0
    s_cmp_ge_u32 s8, 0x10000
    s_cbranch_scc1 L_tbar
    s_branch L_oc13
L_or00:
    s_add_u32 s79, s79, 1
    s_cmp_gt_u32 s79, 262144
    s_cbranch_scc1 L_og00
    ds_read_b32 v51, v50
    s_add_u32 s7, s20, 0
    buffer_load_dwordx4 v[128:131], v5, s[60:63], s7 offen sc1
    s_add_u32 s7, s20, 4096
    buffer_load_dwordx4 v[132:135], v5, s[60:63], s7 offen sc1
    s_add_u32 s7, s20, 8192
    buffer_load_dwordx4 v[136:139], v5, s[60:63], s7 offen sc1
    s_add_u32 s7, s20, 12288
    buffer_load_dwordx4 v[140:143], v5, s[60:63], s7 offen sc1
    s_add_u32 s7, s20, 16384
    buffer_load_dwordx4 v[144:147], v5, s[60:63], s7 offen sc1
    s_add_u32 s7, s20, 20480
    buffer_load_dwordx4 v[148:151], v5, s[60:63], s7 offen sc1
    s_add_u32 s7, s20, 24576
    buffer_load_dwordx4 v[152:155], v5, s[60:63], s7 offen sc1
    s_add_u32 s7, s20, 28672
    buffer_load_dwordx4 v[156:159], v5, s[60:63], s7 offen sc1
    s_waitcnt lgkmcnt(0)
    v_readfirstlane_b32 s8, v51
    s_nop 0
    s_cmp_ge_u32 s8, 0x10000
    s_cbranch_scc1 L_tbar
    s_branch L_oc00
L_or01:
    s_add_u32 s79, s79, 1
    s_cmp_gt_u32 s79, 262144
    s_cbranch_scc1 L_og01
    ds_read_b32 v51, v50
    s_add_u32 s7, s20, 8192
    buffer_load_dwordx4 v[136:139], v5, s[60:63], s7 offen sc1
    s_add_u32 s7, s20, 12288
    buffer_load_dwordx4 v[140:143], v5, s[60:63], s7 offen sc1
    s_add_u32 s7, s20, 16384
    buffer_load_dwordx4 v[144:147], v5, s[60:63], s7 offen sc1
    s_add_u32 s7, s20, 20480
    buffer_load_dwordx4 v[148:151], v5, s[60:63], s7 offen sc1
    s_add_u32 s7, s20, 24576
    buffer_load_dwordx4 v[152:155], v5, s[60:63], s7 offen sc1
    s_add_u32 s7, s20, 28672
    buffer_load_dwordx4 v[156:159], v5, s[60:63], s7 offen sc1
    s_waitcnt lgkmcnt(0)
    v_readfirstlane_b32 s8, v51
    s_nop 0
    s_cmp_ge_u32 s8, 0x10000
    s_cbranch_scc1 L_tbar
    s_branch L_oc01
L_or02:
    s_add_u32 s79, s79, 1
    s_cmp_gt_u32 s79, 262144
    s_cbranch_scc1 L_og02
    ds_read_b32 v51, v50
    s_add_u32 s7, s20, 16384
    buffer_load_dwordx4 v[144:147], v5, s[60:63], s7 offen sc1
    s_add_u32 s7, s20, 20480
    buffer_load_dwordx4 v[148:151], v5, s[60:63], s7 offen sc1
    s_add_u32 s7, s20, 24576
    buffer_load_dwordx4 v[152:155], v5, s[60:63], s7 offen sc1
    s_add_u32 s7, s20, 28672
    buffer_load_dwordx4 v[156:159], v5, s[60:63], s7 offen sc1
    s_waitcnt lgkmcnt(0)
    v_readfirstlane_b32 s8, v51
    s_nop 0
    s_cmp_ge_u32 s8, 0x10000
    s_cbranch_scc1 L_tbar
    s_branch L_oc02
L_or03:
    s_add_u32 s79, s79, 1
    s_cmp_gt_u32 s79, 262144
    s_cbranch_scc1 L_og03
    ds_read_b32 v51, v50
    s_add_u32 s7, s20, 24576
    buffer_load_dwordx4 v[152:155], v5, s[60:63], s7 offen sc1
    s_add_u32 s7, s20, 28672
    buffer_load_dwordx4 v[156:159], v5, s[60:63], s7 offen sc1
    s_waitcnt lgkmcnt(0)
    v_readfirstlane_b32 s8, v51
    s_nop 0
    s_cmp_ge_u32 s8, 0x10000
    s_cbranch_scc1 L_tbar
    s_branch L_oc03
L_hook2:
    s_cmp_eq_u32 s3, 3
    s_cbranch_scc0 L_hook2_1
    s_cmp_eq_u32 s77, 1
    s_cbranch_scc0 L_hret2
    s_mov_b32 s56, s30
    s_mov_b32 s57, s31
    s_mov_b32 s58, 1835008
    s_mov_b32 s59, 0x20000
    s_mov_b32 s72, s32
    s_mov_b32 s73, s33
    s_mov_b32 s74, 1835008
    s_mov_b32 s75, 0x20000
    s_xor_b32 s6, s5, 0
    s_lshl_b32 s8, s6, 10
    s_add_u32 m0, s8, 98304
    s_mul_i32 s7, s6, 229376
    buffer_load_dwordx4 v11, s[56:59], s7 offen lds
    s_add_u32 m0, s8, 106560
    s_nop 0
    buffer_load_dwordx4 v11, s[72:75], s7 offen lds
    s_xor_b32 s6, s5, 1
    s_lshl_b32 s8, s6, 10
    s_add_u32 m0, s8, 98304
    s_mul_i32 s7, s6, 229376
    buffer_load_dwordx4 v11, s[56:59], s7 offen lds
    s_add_u32 m0, s8, 106560
    s_nop 0
    buffer_load_dwordx4 v11, s[72:75], s7 offen lds
    s_branch L_hret2
L_hook2_1:
    s_cmp_eq_u32 s3, 0
    s_cbranch_scc0 L_hook2_2
    v_mov_b32 v20, -1
    v_mov_b32 v21, -1
    v_mov_b32 v22, -1
    v_mov_b32 v23, -1
    s_lshl_b32 s7, s4, 16
    s_lshl_b32 s8, s5, 12
    s_add_u32 s7, s7, s8
    s_add_u32 s7, s7, 1048576
    buffer_store_dwordx4 v[20:23], v5, s[60:63], s7 offen offset:0 sc1
    buffer_store_dwordx4 v[20:23], v5, s[60:63], s7 offen offset:1024 sc1
    buffer_store_dwordx4 v[20:23], v5, s[60:63], s7 offen offset:2048 sc1
    buffer_store_dwordx4 v[20:23], v5, s[60:63], s7 offen offset:3072 sc1
    s_add_u32 s7, s7, 32768
    buffer_store_dwordx4 v[20:23], v5, s[60:63], s7 offen offset:0 sc1
    buffer_store_dwordx4 v[20:23], v5, s[60:63], s7 offen offset:1024 sc1
    buffer_store_dwordx4 v[20:23], v5, s[60:63], s7 offen offset:2048 sc1
    buffer_store_dwordx4 v[20:23], v5, s[60:63], s7 offen offset:3072 sc1
    s_branch L_hret2
L_hook2_2:
    s_mov_b32 m0, 0
    s_mov_b32 s7, 0
    buffer_load_dwordx4 v10, s[52:55], s7 offen lds
    s_mov_b32 m0, 1024
    s_mov_b32 s7, 4096
    buffer_load_dwordx4 v10, s[52:55], s7 offen lds
    s_mov_b32 m0, 2048
    s_mov_b32 s7, 8192
    buffer_load_dwordx4 v10, s[52:55], s7 offen lds
    s_mov_b32 m0, 3072
    s_mov_b32 s7, 12288
    buffer_load_dwordx4 v10, s[52:55], s7 offen lds
    s_mov_b32 m0, 4096
    s_mov_b32 s7, 16384
    buffer_load_dwordx4 v10, s[52:55], s7 offen lds
    s_mov_b32 m0, 5120
    s_mov_b32 s7, 20480
    buffer_load_dwordx4 v10, s[52:55], s7 offen lds
    s_mov_b32 m0, 6144
    s_mov_b32 s7, 24576
    buffer_load_dwordx4 v10, s[52:55], s7 offen lds
    s_mov_b32 m0, 7168
    s_mov_b32 s7, 28672
    buffer_load_dwordx4 v10, s[52:55], s7 offen lds
    s_mov_b32 m0, 8192
    s_mov_b32 s7, 32768
    buffer_load_dwordx4 v10, s[52:55], s7 offen lds
    s_mov_b32 m0, 9216
    s_mov_b32 s7, 36864
    buffer_load_dwordx4 v10, s[52:55], s7 offen lds
    s_mov_b32 m0, 10240
    s_mov_b32 s7, 40960
    buffer_load_dwordx4 v10, s[52:55], s7 offen lds
    s_mov_b32 m0, 11264
    s_mov_b32 s7, 45056
    buffer_load_dwordx4 v10, s[52:55], s7 offen lds
    s_mov_b32 m0, 12288
    s_mov_b32 s7, 49152
    buffer_load_dwordx4 v10, s[52:55], s7 offen lds
    s_mov_b32 m0, 13312
    s_mov_b32 s7, 53248
    buffer_load_dwordx4 v10, s[52:55], s7 offen lds
    s_mov_b32 m0, 14336
    s_mov_b32 s7, 57344
    buffer_load_dwordx4 v10, s[52:55], s7 offen lds
    s_mov_b32 m0, 15360
    s_mov_b32 s7, 61440
    buffer_load_dwordx4 v10, s[52:55], s7 offen lds
    s_mov_b32 m0, 16384
    s_mov_b32 s7, 65536
    buffer_load_dwordx4 v10, s[52:55], s7 offen lds
    s_mov_b32 m0, 17408
    s_mov_b32 s7, 69632
    buffer_load_dwordx4 v10, s[52:55], s7 offen lds
    s_mov_b32 m0, 18432
    s_mov_b32 s7, 73728
    buffer_load_dwordx4 v10, s[52:55], s7 offen lds
    s_mov_b32 m0, 19456
    s_mov_b32 s7, 77824
    buffer_load_dwordx4 v10, s[52:55], s7 offen lds
    s_mov_b32 m0, 20480
    s_mov_b32 s7, 81920
    buffer_load_dwordx4 v10, s[52:55], s7 offen lds
    s_mov_b32 m0, 21504
    s_mov_b32 s7, 86016
    buffer_load_dwordx4 v10, s[52:55], s7 offen lds
    s_mov_b32 m0, 22528
    s_mov_b32 s7, 90112
    buffer_load_dwordx4 v10, s[52:55], s7 offen lds
    s_mov_b32 m0, 23552
    s_mov_b32 s7, 94208
    buffer_load_dwordx4 v10, s[52:55], s7 offen lds
    s_mov_b32 m0, 24576
    s_mov_b32 s7, 98304
    buffer_load_dwordx4 v10, s[52:55], s7 offen lds
    s_mov_b32 m0, 25600
    s_mov_b32 s7, 102400
    buffer_load_dwordx4 v10, s[52:55], s7 offen lds
    s_mov_b32 m0, 26624
    s_mov_b32 s7, 106496
    buffer_load_dwordx4 v10, s[52:55], s7 offen lds
    s_mov_b32 m0, 27648
    s_mov_b32 s7, 110592
    buffer_load_dwordx4 v10, s[52:55], s7 offen lds
    s_mov_b32 m0, 28672
    s_mov_b32 s7, 114688
    buffer_load_dwordx4 v10, s[52:55], s7 offen lds
    s_mov_b32 m0, 29696
    s_mov_b32 s7, 118784
    buffer_load_dwordx4 v10, s[52:55], s7 offen lds
    s_mov_b32 m0, 30720
    s_mov_b32 s7, 122880
    buffer_load_dwordx4 v10, s[52:55], s7 offen lds
    s_mov_b32 m0, 31744
    s_mov_b32 s7, 126976
    buffer_load_dwordx4 v10, s[52:55], s7 offen lds
    s_branch L_hret2
L_hook3:
    s_cmp_eq_u32 s77, 1
    s_cbranch_scc0 L_hret3
    s_mov_b32 s56, s30
    s_mov_b32 s57, s31
    s_mov_b32 s58, 1835008
    s_mov_b32 s59, 0x20000
    s_mov_b32 s72, s32
    s_mov_b32 s73, s33
    s_mov_b32 s74, 1835008
    s_mov_b32 s75, 0x20000
    s_xor_b32 s6, s5, 2
    s_lshl_b32 s8, s6, 10
    s_add_u32 m0, s8, 98304
    s_mul_i32 s7, s6, 229376
    buffer_load_dwordx4 v11, s[56:59], s7 offen lds
    s_add_u32 m0, s8, 106560
    s_nop 0
    buffer_load_dwordx4 v11, s[72:75], s7 offen lds
    s_xor_b32 s6, s5, 3
    s_lshl_b32 s8, s6, 10
    s_add_u32 m0, s8, 98304
    s_mul_i32 s7, s6, 229376
    buffer_load_dwordx4 v11, s[56:59], s7 offen lds
    s_add_u32 m0, s8, 106560
    s_nop 0
    buffer_load_dwordx4 v11, s[72:75], s7 offen lds
    s_branch L_hret3
L_hook4:
    s_cmp_eq_u32 s3, 3
    s_cbranch_scc0 L_hook4_1
    s_cmp_eq_u32 s77, 1
    s_cbranch_scc0 L_hret4
    s_mov_b32 s56, s30
    s_mov_b32 s57, s31
    s_mov_b32 s58, 1835008
    s_mov_b32 s59, 0x20000
    s_mov_b32 s72, s32
    s_mov_b32 s73, s33
    s_mov_b32 s74, 1835008
    s_mov_b32 s75, 0x20000
    s_xor_b32 s6, s5, 4
    s_lshl_b32 s8, s6, 10
    s_add_u32 m0, s8, 98304
    s_mul_i32 s7, s6, 229376
    buffer_load_dwordx4 v11, s[56:59], s7 offen lds
    s_add_u32 m0, s8, 106560
    s_nop 0
    buffer_load_dwordx4 v11, s[72:75], s7 offen lds
    s_xor_b32 s6, s5, 5
    s_lshl_b32 s8, s6, 10
    s_add_u32 m0, s8, 98304
    s_mul_i32 s7, s6, 229376
    buffer_load_dwordx4 v11, s[56:59], s7 offen lds
    s_add_u32 m0, s8, 106560
    s_nop 0
    buffer_load_dwordx4 v11, s[72:75], s7 offen lds
    s_branch L_hret4
L_hook4_1:
    s_mov_b32 m0, 65536
    s_mov_b32 s7, 262144
    buffer_load_dwordx4 v10, s[52:55], s7 offen lds
    s_mov_b32 m0, 66560
    s_mov_b32 s7, 266240
    buffer_load_dwordx4 v10, s[52:55], s7 offen lds
    s_mov_b32 m0, 67584
    s_mov_b32 s7, 270336
    buffer_load_dwordx4 v10, s[52:55], s7 offen lds
    s_mov_b32 m0, 68608
    s_mov_b32 s7, 274432
    buffer_load_dwordx4 v10, s[52:55], s7 offen lds
    s_mov_b32 m0, 69632
    s_mov_b32 s7, 278528
    buffer_load_dwordx4 v10, s[52:55], s7 offen lds
    s_mov_b32 m0, 70656
    s_mov_b32 s7, 282624
    buffer_load_dwordx4 v10, s[52:55], s7 offen lds
    s_mov_b32 m0, 71680
    s_mov_b32 s7, 286720
    buffer_load_dwordx4 v10, s[52:55], s7 offen lds
    s_mov_b32 m0, 72704
    s_mov_b32 s7, 290816
    buffer_load_dwordx4 v10, s[52:55], s7 offen lds
    s_mov_b32 m0, 73728
    s_mov_b32 s7, 294912
    buffer_load_dwordx4 v10, s[52:55], s7 offen lds
    s_mov_b32 m0, 74752
    s_mov_b32 s7, 299008
    buffer_load_dwordx4 v10, s[52:55], s7 offen lds
    s_mov_b32 m0, 75776
    s_mov_b32 s7, 303104
    buffer_load_dwordx4 v10, s[52:55], s7 offen lds
    s_mov_b32 m0, 76800
    s_mov_b32 s7, 307200
    buffer_load_dwordx4 v10, s[52:55], s7 offen lds
    s_mov_b32 m0, 77824
    s_mov_b32 s7, 311296
    buffer_load_dwordx4 v10, s[52:55], s7 offen lds
    s_mov_b32 m0, 78848
    s_mov_b32 s7, 315392
    buffer_load_dwordx4 v10, s[52:55], s7 offen lds
    s_mov_b32 m0, 79872
    s_mov_b32 s7, 319488
    buffer_load_dwordx4 v10, s[52:55], s7 offen lds
    s_mov_b32 m0, 80896
    s_mov_b32 s7, 323584
    buffer_load_dwordx4 v10, s[52:55], s7 offen lds
    s_mov_b32 m0, 81920
    s_mov_b32 s7, 327680
    buffer_load_dwordx4 v10, s[52:55], s7 offen lds
    s_mov_b32 m0, 82944
    s_mov_b32 s7, 331776
    buffer_load_dwordx4 v10, s[52:55], s7 offen lds
    s_mov_b32 m0, 83968
    s_mov_b32 s7, 335872
    buffer_load_dwordx4 v10, s[52:55], s7 offen lds
    s_mov_b32 m0, 84992
    s_mov_b32 s7, 339968
    buffer_load_dwordx4 v10, s[52:55], s7 offen lds
    s_mov_b32 m0, 86016
    s_mov_b32 s7, 344064
    buffer_load_dwordx4 v10, s[52:55], s7 offen lds
    s_mov_b32 m0, 87040
    s_mov_b32 s7, 348160
    buffer_load_dwordx4 v10, s[52:55], s7 offen lds
    s_mov_b32 m0, 88064
    s_mov_b32 s7, 352256
    buffer_load_dwordx4 v10, s[52:55], s7 offen lds
    s_mov_b32 m0, 89088
    s_mov_b32 s7, 356352
    buffer_load_dwordx4 v10, s[52:55], s7 offen lds
    s_mov_b32 m0, 90112
    s_mov_b32 s7, 360448
    buffer_load_dwordx4 v10, s[52:55], s7 offen lds
    s_mov_b32 m0, 91136
    s_mov_b32 s7, 364544
    buffer_load_dwordx4 v10, s[52:55], s7 offen lds
    s_mov_b32 m0, 92160
    s_mov_b32 s7, 368640
    buffer_load_dwordx4 v10, s[52:55], s7 offen lds
    s_mov_b32 m0, 93184
    s_mov_b32 s7, 372736
    buffer_load_dwordx4 v10, s[52:55], s7 offen lds
    s_mov_b32 m0, 94208
    s_mov_b32 s7, 376832
    buffer_load_dwordx4 v10, s[52:55], s7 offen lds
    s_mov_b32 m0, 95232
    s_mov_b32 s7, 380928
    buffer_load_dwordx4 v10, s[52:55], s7 offen lds
    s_mov_b32 m0, 96256
    s_mov_b32 s7, 385024
    buffer_load_dwordx4 v10, s[52:55], s7 offen lds
    s_mov_b32 m0, 97280
    s_mov_b32 s7, 389120
    buffer_load_dwordx4 v10, s[52:55], s7 offen lds
    s_branch L_hret4
L_hook5:
    s_cmp_eq_u32 s77, 1
    s_cbranch_scc0 L_hret5
    s_mov_b32 s56, s30
    s_mov_b32 s57, s31
    s_mov_b32 s58, 1835008
    s_mov_b32 s59, 0x20000
    s_mov_b32 s72, s32
    s_mov_b32 s73, s33
    s_mov_b32 s74, 1835008
    s_mov_b32 s75, 0x20000
    s_xor_b32 s6, s5, 6
    s_lshl_b32 s8, s6, 10
    s_add_u32 m0, s8, 98304
    s_mul_i32 s7, s6, 229376
    buffer_load_dwordx4 v11, s[56:59], s7 offen lds
    s_add_u32 m0, s8, 106560
    s_nop 0
    buffer_load_dwordx4 v11, s[72:75], s7 offen lds
    s_xor_b32 s6, s5, 7
    s_lshl_b32 s8, s6, 10
    s_add_u32 m0, s8, 98304
    s_mul_i32 s7, s6, 229376
    buffer_load_dwordx4 v11, s[56:59], s7 offen lds
    s_add_u32 m0, s8, 106560
    s_nop 0
    buffer_load_dwordx4 v11, s[72:75], s7 offen lds
    s_branch L_hret5
L_hook6:
    s_cmp_eq_u32 s3, 0
    s_cbranch_scc0 L_hook6_1
    s_waitcnt vmcnt(0)
    s_mov_b64 exec, 1
    s_getreg_b32 s7, hwreg(HW_REG_XCC_ID, 0, 4)
    v_mov_b32 v6, s68
    v_mov_b32 v7, s7
    s_lshl_b32 s6, s70, 7
    s_add_u32 s6, s6, 262160
    buffer_store_dwordx2 v[6:7], v4, s[60:63], s6 offen sc1
    s_mov_b64 exec, -1
    s_branch L_hret6
L_hook6_1:
    s_cmp_eq_u32 s3, 1
    s_cbranch_scc0 L_hook6_2
    s_mov_b32 m0, 32768
    s_mov_b32 s7, 131072
    buffer_load_dwordx4 v10, s[52:55], s7 offen lds
    s_mov_b32 m0, 33792
    s_mov_b32 s7, 135168
    buffer_load_dwordx4 v10, s[52:55], s7 offen lds
    s_mov_b32 m0, 34816
    s_mov_b32 s7, 139264
    buffer_load_dwordx4 v10, s[52:55], s7 offen lds
    s_mov_b32 m0, 35840
    s_mov_b32 s7, 143360
    buffer_load_dwordx4 v10, s[52:55], s7 offen lds
    s_mov_b32 m0, 36864
    s_mov_b32 s7, 147456
    buffer_load_dwordx4 v10, s[52:55], s7 offen lds
    s_mov_b32 m0, 37888
    s_mov_b32 s7, 151552
    buffer_load_dwordx4 v10, s[52:55], s7 offen lds
    s_mov_b32 m0, 38912
    s_mov_b32 s7, 155648
    buffer_load_dwordx4 v10, s[52:55], s7 offen lds
    s_mov_b32 m0, 39936
    s_mov_b32 s7, 159744
    buffer_load_dwordx4 v10, s[52:55], s7 offen lds
    s_mov_b32 m0, 40960
    s_mov_b32 s7, 163840
    buffer_load_dwordx4 v10, s[52:55], s7 offen lds
    s_mov_b32 m0, 41984
    s_mov_b32 s7, 167936
    buffer_load_dwordx4 v10, s[52:55], s7 offen lds
    s_mov_b32 m0, 43008
    s_mov_b32 s7, 172032
    buffer_load_dwordx4 v10, s[52:55], s7 offen lds
    s_mov_b32 m0, 44032
    s_mov_b32 s7, 176128
    buffer_load_dwordx4 v10, s[52:55], s7 offen lds
    s_mov_b32 m0, 45056
    s_mov_b32 s7, 180224
    buffer_load_dwordx4 v10, s[52:55], s7 offen lds
    s_mov_b32 m0, 46080
    s_mov_b32 s7, 184320
    buffer_load_dwordx4 v10, s[52:55], s7 offen lds
    s_mov_b32 m0, 47104
    s_mov_b32 s7, 188416
    buffer_load_dwordx4 v10, s[52:55], s7 offen lds
    s_mov_b32 m0, 48128
    s_mov_b32 s7, 192512
    buffer_load_dwordx4 v10, s[52:55], s7 offen lds
    s_mov_b32 m0, 49152
    s_mov_b32 s7, 196608
    buffer_load_dwordx4 v10, s[52:55], s7 offen lds
    s_mov_b32 m0, 50176
    s_mov_b32 s7, 200704
    buffer_load_dwordx4 v10, s[52:55], s7 offen lds
    s_mov_b32 m0, 51200
    s_mov_b32 s7, 204800
    buffer_load_dwordx4 v10, s[52:55], s7 offen lds
    s_mov_b32 m0, 52224
    s_mov_b32 s7, 208896
    buffer_load_dwordx4 v10, s[52:55], s7 offen lds
    s_mov_b32 m0, 53248
    s_mov_b32 s7, 212992
    buffer_load_dwordx4 v10, s[52:55], s7 offen lds
    s_mov_b32 m0, 54272
    s_mov_b32 s7, 217088
    buffer_load_dwordx4 v10, s[52:55], s7 offen lds
    s_mov_b32 m0, 55296
    s_mov_b32 s7, 221184
    buffer_load_dwordx4 v10, s[52:55], s7 offen lds
    s_mov_b32 m0, 56320
    s_mov_b32 s7, 225280
    buffer_load_dwordx4 v10, s[52:55], s7 offen lds
    s_mov_b32 m0, 57344
    s_mov_b32 s7, 229376
    buffer_load_dwordx4 v10, s[52:55], s7 offen lds
    s_mov_b32 m0, 58368
    s_mov_b32 s7, 233472
    buffer_load_dwordx4 v10, s[52:55], s7 offen lds
    s_mov_b32 m0, 59392
    s_mov_b32 s7, 237568
    buffer_load_dwordx4 v10, s[52:55], s7 offen lds
    s_mov_b32 m0, 60416
    s_mov_b32 s7, 241664
    buffer_load_dwordx4 v10, s[52:55], s7 offen lds
    s_mov_b32 m0, 61440
    s_mov_b32 s7, 245760
    buffer_load_dwordx4 v10, s[52:55], s7 offen lds
    s_mov_b32 m0, 62464
    s_mov_b32 s7, 249856
    buffer_load_dwordx4 v10, s[52:55], s7 offen lds
    s_mov_b32 m0, 63488
    s_mov_b32 s7, 253952
    buffer_load_dwordx4 v10, s[52:55], s7 offen lds
    s_mov_b32 m0, 64512
    s_mov_b32 s7, 258048
    buffer_load_dwordx4 v10, s[52:55], s7 offen lds
    s_branch L_hret6
L_hook6_2:
    s_cmp_eq_u32 s3, 3
    s_cbranch_scc0 L_hook6_3
    s_cmp_eq_u32 s77, 1
    s_cbranch_scc0 L_hret6
    s_mov_b32 s56, s34
    s_mov_b32 s57, s35
    s_mov_b32 s58, 1835008
    s_mov_b32 s59, 0x20000
    s_lshl_b32 s6, s76, 10
    s_mov_b32 m0, 114816
    s_add_u32 s7, s6, 0
    buffer_load_dwordx4 v5, s[56:59], s7 offen lds
    s_mov_b32 m0, 115904
    s_add_u32 s7, s6, 1024
    buffer_load_dwordx4 v5, s[56:59], s7 offen lds
    s_mov_b32 m0, 116992
    s_add_u32 s7, s6, 2048
    buffer_load_dwordx4 v5, s[56:59], s7 offen lds
    s_mov_b32 m0, 118080
    s_add_u32 s7, s6, 3072
    buffer_load_dwordx4 v5, s[56:59], s7 offen lds
    s_mov_b32 m0, 119168
    s_add_u32 s7, s6, 4096
    buffer_load_dwordx4 v5, s[56:59], s7 offen lds
    s_mov_b32 m0, 120256
    s_add_u32 s7, s6, 5120
    buffer_load_dwordx4 v5, s[56:59], s7 offen lds
    s_mov_b32 m0, 121344
    s_add_u32 s7, s6, 6144
    buffer_load_dwordx4 v5, s[56:59], s7 offen lds
    s_mov_b32 m0, 122432
    s_add_u32 s7, s6, 7168
    buffer_load_dwordx4 v5, s[56:59], s7 offen lds
    s_mov_b32 m0, 123520
    s_lshl_b32 s7, s14, 10
    buffer_load_dwordx4 v5, s[44:47], s7 offen lds
    s_branch L_hret6
L_hook6_3:
    v_mov_b32 v7, 1
    s_waitcnt vmcnt(0)
    s_mov_b64 exec, 1
    ds_add_u32 v52, v7
    s_mov_b64 exec, -1
    s_branch L_hret6
L_hook8:
    s_cmp_eq_u32 s3, 3
    s_cbranch_scc0 L_hook8_1
    s_cmp_eq_u32 s77, 1
    s_cbranch_scc0 L_ffn_e
    s_waitcnt vmcnt(0)
    ds_read_b64_tr_b16 v[20:21], v8 offset:0
    ds_read_b64_tr_b16 v[22:23], v8 offset:64
    ds_read_b128 v[24:27], v9 offset:25216
    ds_read_b64_tr_b16 v[28:29], v8 offset:512
    ds_read_b64_tr_b16 v[30:31], v8 offset:576
    ds_read_b128 v[32:35], v9 offset:25280
    ds_read_b64_tr_b16 v[36:37], v8 offset:1024
    ds_read_b64_tr_b16 v[38:39], v8 offset:1088
    ds_read_b128 v[40:43], v9 offset:25344
    s_mov_b32 s18, 0x22222222
    s_mov_b32 s19, 0x22222222
    s_mov_b32 s20, 0x44444444
    s_mov_b32 s21, 0x44444444
    s_mov_b32 s22, 0x88888888
    s_mov_b32 s23, 0x88888888
    s_waitcnt lgkmcnt(6)
    v_mfma_f32_16x16x32_bf16 v[44:47], v[20:23], v[24:27], 0
    ds_read_b64_tr_b16 v[20:21], v8 offset:1536
    ds_read_b64_tr_b16 v[22:23], v8 offset:1600
    ds_read_b128 v[24:27], v9 offset:25408
    s_waitcnt lgkmcnt(6)
    v_mfma_f32_16x16x32_bf16 v[44:47], v[28:31], v[32:35], v[44:47]
    ds_read_b64_tr_b16 v[28:29], v8 offset:2048
    ds_read_b64_tr_b16 v[30:31], v8 offset:2112
    ds_read_b128 v[32:35], v9 offset:25472
    s_waitcnt lgkmcnt(6)
    v_mfma_f32_16x16x32_bf16 v[44:47], v[36:39], v[40:43], v[44:47]
    ds_read_b64_tr_b16 v[36:37], v8 offset:2560
    ds_read_b64_tr_b16 v[38:39], v8 offset:2624
    ds_read_b128 v[40:43], v9 offset:25536
    s_waitcnt lgkmcnt(6)
    v_mfma_f32_16x16x32_bf16 v[44:47], v[20:23], v[24:27], v[44:47]
    ds_read_b64_tr_b16 v[20:21], v8 offset:3072
    ds_read_b64_tr_b16 v[22:23], v8 offset:3136
    ds_read_b128 v[24:27], v9 offset:25600
    s_waitcnt lgkmcnt(6)
    v_mfma_f32_16x16x32_bf16 v[44:47], v[28:31], v[32:35], v[44:47]
    ds_read_b64_tr_b16 v[28:29], v8 offset:3584
    ds_read_b64_tr_b16 v[30:31], v8 offset:3648
    ds_read_b128 v[32:35], v9 offset:25664
    s_waitcnt lgkmcnt(6)
    v_mfma_f32_16x16x32_bf16 v[44:47], v[36:39], v[40:43], v[44:47]
    ds_read_b64_tr_b16 v[36:37], v8 offset:4096
    ds_read_b64_tr_b16 v[38:39], v8 offset:4160
    ds_read_b128 v[40:43], v9 offset:25728
    s_waitcnt lgkmcnt(6)
    v_mfma_f32_16x16x32_bf16 v[44:47], v[20:23], v[24:27], v[44:47]
    ds_read_b64_tr_b16 v[20:21], v8 offset:4608
    ds_read_b64_tr_b16 v[22:23], v8 offset:4672
    ds_read_b128 v[24:27], v9 offset:25792
    s_waitcnt lgkmcnt(6)
    v_mfma_f32_16x16x32_bf16 v[44:47], v[28:31], v[32:35], v[44:47]
    ds_read_b64_tr_b16 v[28:29], v8 offset:5120
    ds_read_b64_tr_b16 v[30:31], v8 offset:5184
    ds_read_b128 v[32:35], v9 offset:25856
    s_waitcnt lgkmcnt(6)
    v_mfma_f32_16x16x32_bf16 v[44:47], v[36:39], v[40:43], v[44:47]
    ds_read_b64_tr_b16 v[36:37], v8 offset:5632
    ds_read_b64_tr_b16 v[38:39], v8 offset:5696
    ds_read_b128 v[40:43], v9 offset:25920
    s_waitcnt lgkmcnt(6)
    v_mfma_f32_16x16x32_bf16 v[44:47], v[20:23], v[24:27], v[44:47]
    ds_read_b64_tr_b16 v[20:21], v8 offset:6144
    ds_read_b64_tr_b16 v[22:23], v8 offset:6208
    ds_read_b128 v[24:27], v9 offset:25984
    s_waitcnt lgkmcnt(6)
    v_mfma_f32_16x16x32_bf16 v[44:47], v[28:31], v[32:35], v[44:47]
    ds_read_b64_tr_b16 v[28:29], v8 offset:6656
    ds_read_b64_tr_b16 v[30:31], v8 offset:6720
    ds_read_b128 v[32:35], v9 offset:26048
    s_waitcnt lgkmcnt(6)
    v_mfma_f32_16x16x32_bf16 v[44:47], v[36:39], v[40:43], v[44:47]
    ds_read_b64_tr_b16 v[36:37], v8 offset:7168
    ds_read_b64_tr_b16 v[38:39], v8 offset:7232
    ds_read_b128 v[40:43], v9 offset:26112
    s_waitcnt lgkmcnt(6)
    v_mfma_f32_16x16x32_bf16 v[44:47], v[20:23], v[24:27], v[44:47]
    ds_read_b64_tr_b16 v[20:21], v8 offset:7680
    ds_read_b64_tr_b16 v[22:23], v8 offset:7744
    ds_read_b128 v[24:27], v9 offset:26176
    s_waitcnt lgkmcnt(6)
    v_mfma_f32_16x16x32_bf16 v[44:47], v[28:31], v[32:35], v[44:47]
    s_waitcnt lgkmcnt(3)
    v_mfma_f32_16x16x32_bf16 v[44:47], v[36:39], v[40:43], v[44:47]
    s_waitcnt lgkmcnt(0)
    v_mfma_f32_16x16x32_bf16 v[44:47], v[20:23], v[24:27], v[44:47]
    ds_read_b64_tr_b16 v[20:21], v16 offset:16512
    ds_read_b64_tr_b16 v[22:23], v16 offset:20864
    ds_read_b64_tr_b16 v[24:25], v16 offset:16640
    ds_read_b64_tr_b16 v[26:27], v16 offset:20992
    ds_read_b64_tr_b16 v[28:29], v16 offset:16768
    ds_read_b64_tr_b16 v[30:31], v16 offset:21120
    ds_read_b64_tr_b16 v[32:33], v16 offset:16896
    ds_read_b64_tr_b16 v[34:35], v16 offset:21248
    v_cndmask_b32 v44, v44, v45, s[18:19]
    v_cndmask_b32 v44, v44, v46, s[20:21]
    v_cndmask_b32 v44, v44, v47, s[22:23]
    v_cvt_pk_bf16_f32 v44, v44, v44
    v_and_b32 v44, 0xffff0000, v44
    v_mov_b32 v45, v44
    s_nop 1
    v_permlane32_swap_b32 v44, v45
    v_mul_f32 v46, 0xbfb8aa3b, v44
    v_exp_f32 v46, v46
    s_nop 0
    v_add_f32 v46, 1.0, v46
    v_rcp_f32 v46, v46
    s_nop 0
    v_mul_f32 v44, v44, v46
    v_cvt_pk_bf16_f32 v44, v44, v44
    v_and_b32 v44, 0xffff0000, v44
    v_mul_f32 v44, v44, v45
    v_cvt_pk_bf16_f32 v44, v44, v44
    s_mov_b64 exec, 0xf000f
    ds_write_b16 v0, v44
    s_mov_b64 exec, -1
    ds_read_b128 v[48:51], v17
    s_and_b32 s6, s2, 7
    s_lshl_b32 s6, s6, 11
    s_add_u32 s6, s6, 131072
    s_waitcnt lgkmcnt(0)
    v_mfma_f32_16x16x32_bf16 v[36:39], v[48:51], v[20:23], 0
    v_mfma_f32_16x16x32_bf16 v[40:43], v[48:51], v[24:27], 0
    v_mfma_f32_16x16x32_bf16 v[44:47], v[48:51], v[28:31], 0
    v_mfma_f32_16x16x32_bf16 v[12:15], v[48:51], v[32:35], 0
    ds_read_b64_tr_b16 v[20:21], v16 offset:17024
    ds_read_b64_tr_b16 v[22:23], v16 offset:21376
    ds_read_b64_tr_b16 v[24:25], v16 offset:17152
    ds_read_b64_tr_b16 v[26:27], v16 offset:21504
    ds_read_b64_tr_b16 v[28:29], v16 offset:17280
    ds_read_b64_tr_b16 v[30:31], v16 offset:21632
    ds_read_b64_tr_b16 v[32:33], v16 offset:17408
    ds_read_b64_tr_b16 v[34:35], v16 offset:21760
    buffer_atomic_add_f32 v36, v4, s[60:63], s6 offen offset:0
    buffer_atomic_add_f32 v40, v4, s[60:63], s6 offen offset:256
    buffer_atomic_add_f32 v44, v4, s[60:63], s6 offen offset:512
    buffer_atomic_add_f32 v12, v4, s[60:63], s6 offen offset:768
    s_waitcnt lgkmcnt(0)
    v_mfma_f32_16x16x32_bf16 v[36:39], v[48:51], v[20:23], 0
    v_mfma_f32_16x16x32_bf16 v[40:43], v[48:51], v[24:27], 0
    v_mfma_f32_16x16x32_bf16 v[44:47], v[48:51], v[28:31], 0
    v_mfma_f32_16x16x32_bf16 v[12:15], v[48:51], v[32:35], 0
    s_nop 4
    buffer_atomic_add_f32 v36, v4, s[60:63], s6 offen offset:1024
    buffer_atomic_add_f32 v40, v4, s[60:63], s6 offen offset:1280
    buffer_atomic_add_f32 v44, v4, s[60:63], s6 offen offset:1536
    buffer_atomic_add_f32 v12, v4, s[60:63], s6 offen offset:1792
L_ffn_e:
    v_mov_b32 v7, 1
    ds_write_b32 v52, v7 offset:4
    s_branch L_hret8
L_hook8_1:
    s_cmp_eq_u32 s3, 5
    s_cbranch_scc0 L_hook8_2
L_fdn_6:
    ds_read_b32 v7, v52 offset:4
    s_waitcnt lgkmcnt(0)
    v_cmp_ne_u32 vcc, 1, v7
    s_nop 1
    s_cbranch_vccnz L_fdn_6
    s_mov_b32 m0, 98304
    s_mov_b32 s7, 393216
    buffer_load_dwordx4 v10, s[52:55], s7 offen lds
    s_mov_b32 m0, 99328
    s_mov_b32 s7, 397312
    buffer_load_dwordx4 v10, s[52:55], s7 offen lds
    s_mov_b32 m0, 100352
    s_mov_b32 s7, 401408
    buffer_load_dwordx4 v10, s[52:55], s7 offen lds
    s_mov_b32 m0, 101376
    s_mov_b32 s7, 405504
    buffer_load_dwordx4 v10, s[52:55], s7 offen lds
    s_mov_b32 m0, 102400
    s_mov_b32 s7, 409600
    buffer_load_dwordx4 v10, s[52:55], s7 offen lds
    s_mov_b32 m0, 103424
    s_mov_b32 s7, 413696
    buffer_load_dwordx4 v10, s[52:55], s7 offen lds
    s_mov_b32 m0, 104448
    s_mov_b32 s7, 417792
    buffer_load_dwordx4 v10, s[52:55], s7 offen lds
    s_mov_b32 m0, 105472
    s_mov_b32 s7, 421888
    buffer_load_dwordx4 v10, s[52:55], s7 offen lds
    s_mov_b32 m0, 106496
    s_mov_b32 s7, 425984
    buffer_load_dwordx4 v10, s[52:55], s7 offen lds
    s_mov_b32 m0, 107520
    s_mov_b32 s7, 430080
    buffer_load_dwordx4 v10, s[52:55], s7 offen lds
    s_mov_b32 m0, 108544
    s_mov_b32 s7, 434176
    buffer_load_dwordx4 v10, s[52:55], s7 offen lds
    s_mov_b32 m0, 109568
    s_mov_b32 s7, 438272
    buffer_load_dwordx4 v10, s[52:55], s7 offen lds
    s_mov_b32 m0, 110592
    s_mov_b32 s7, 442368
    buffer_load_dwordx4 v10, s[52:55], s7 offen lds
    s_mov_b32 m0, 111616
    s_mov_b32 s7, 446464
    buffer_load_dwordx4 v10, s[52:55], s7 offen lds
    s_mov_b32 m0, 112640
    s_mov_b32 s7, 450560
    buffer_load_dwordx4 v10, s[52:55], s7 offen lds
    s_mov_b32 m0, 113664
    s_mov_b32 s7, 454656
    buffer_load_dwordx4 v10, s[52:55], s7 offen lds
    s_mov_b32 m0, 114688
    s_mov_b32 s7, 458752
    buffer_load_dwordx4 v10, s[52:55], s7 offen lds
    s_mov_b32 m0, 115712
    s_mov_b32 s7, 462848
    buffer_load_dwordx4 v10, s[52:55], s7 offen lds
    s_mov_b32 m0, 116736
    s_mov_b32 s7, 466944
    buffer_load_dwordx4 v10, s[52:55], s7 offen lds
    s_mov_b32 m0, 117760
    s_mov_b32 s7, 471040
    buffer_load_dwordx4 v10, s[52:55], s7 offen lds
    s_mov_b32 m0, 118784
    s_mov_b32 s7, 475136
    buffer_load_dwordx4 v10, s[52:55], s7 offen lds
    s_mov_b32 m0, 119808
    s_mov_b32 s7, 479232
    buffer_load_dwordx4 v10, s[52:55], s7 offen lds
    s_mov_b32 m0, 120832
    s_mov_b32 s7, 483328
    buffer_load_dwordx4 v10, s[52:55], s7 offen lds
    s_mov_b32 m0, 121856
    s_mov_b32 s7, 487424
    buffer_load_dwordx4 v10, s[52:55], s7 offen lds
    s_mov_b32 m0, 122880
    s_mov_b32 s7, 491520
    buffer_load_dwordx4 v10, s[52:55], s7 offen lds
    s_mov_b32 m0, 123904
    s_mov_b32 s7, 495616
    buffer_load_dwordx4 v10, s[52:55], s7 offen lds
    s_mov_b32 m0, 124928
    s_mov_b32 s7, 499712
    buffer_load_dwordx4 v10, s[52:55], s7 offen lds
    s_mov_b32 m0, 125952
    s_mov_b32 s7, 503808
    buffer_load_dwordx4 v10, s[52:55], s7 offen lds
    s_mov_b32 m0, 126976
    s_mov_b32 s7, 507904
    buffer_load_dwordx4 v10, s[52:55], s7 offen lds
    s_mov_b32 m0, 128000
    s_mov_b32 s7, 512000
    buffer_load_dwordx4 v10, s[52:55], s7 offen lds
    s_mov_b32 m0, 129024
    s_mov_b32 s7, 516096
    buffer_load_dwordx4 v10, s[52:55], s7 offen lds
    s_mov_b32 m0, 130048
    s_mov_b32 s7, 520192
    buffer_load_dwordx4 v10, s[52:55], s7 offen lds
    s_branch L_hret8
L_hook8_2:
    v_mov_b32 v7, 1
    s_waitcnt vmcnt(0)
    s_mov_b64 exec, 1
    ds_add_u32 v52, v7
    s_mov_b64 exec, -1
    s_branch L_hret8
L_hook10:
    v_mov_b32 v7, 1
    s_waitcnt vmcnt(0)
    s_mov_b64 exec, 1
    ds_add_u32 v52, v7
    s_mov_b64 exec, -1
    s_branch L_hret10
L_hook11:
    s_cmp_eq_u32 s3, 3
    s_cbranch_scc0 L_hook11_1
    s_waitcnt vmcnt(0)
    s_mov_b64 exec, 1
    v_mov_b32 v7, s77
    s_mov_b32 s6, 163840
    buffer_atomic_add v7, v4, s[60:63], s6 offen sc1
    s_mov_b64 exec, -1
    s_branch L_hret11
L_hook11_1:
    v_mov_b32 v7, 1
    s_waitcnt vmcnt(0)
    s_mov_b64 exec, 1
    ds_add_u32 v52, v7
    s_mov_b64 exec, -1
    s_branch L_hret11
L_hook12:
    v_and_b32 v6, 7, v1
    v_lshlrev_b32 v6, 7, v6
    s_lshl_b32 s6, s4, 10
    s_add_u32 s6, s6, 262160
    s_mov_b32 s79, 0
L_gpoll:
    buffer_load_dwordx2 v[20:21], v6, s[60:63], s6 offen sc1
    s_add_u32 s79, s79, 1
    s_waitcnt vmcnt(0)
    v_cmp_ne_u32 vcc, s68, v20
    s_cmp_gt_u32 s79, 262144
    s_cbranch_scc1 L_gpollout
    s_cbranch_vccnz L_gpoll
L_gpollout:
    s_getreg_b32 s7, hwreg(HW_REG_XCC_ID, 0, 4)
    v_cmp_ne_u32 vcc, s7, v21
    s_nop 0
    s_cmp_eq_u64 vcc, 0
    s_cselect_b32 s7, 16777217, 1
    v_mov_b32 v7, s7
    s_waitcnt vmcnt(0)
    s_mov_b64 exec, 1
    ds_add_u32 v52, v7
    s_mov_b64 exec, -1
    s_branch L_hret12
L_hook14:
    v_mov_b32 v6, 0
    s_mov_b32 s6, 163840
    s_mov_b32 s79, 0
L_ypoll:
    buffer_load_dword v7, v6, s[60:63], s6 offen sc1
    s_add_u32 s79, s79, 1
    s_waitcnt vmcnt(0)
    v_readfirstlane_b32 s7, v7
    s_cmp_gt_u32 s79, 262144
    s_cbranch_scc1 L_ypollout
    s_cmp_eq_u32 s7, 224
    s_cbranch_scc0 L_ypoll
L_ypollout:
    s_lshr_b32 s6, s5, 1
    s_lshl_b32 s6, s6, 9
    s_and_b32 s7, s3, 1
    s_lshl_b32 s7, s7, 8
    s_add_u32 s6, s6, s7
    s_lshr_b32 s7, s3, 1
    s_lshl_b32 s7, s7, 7
    s_add_u32 s6, s6, s7
    s_add_u32 s6, s6, 131072
    v_lshrrev_b32 v6, 3, v1
    v_and_b32 v7, 7, v1
    v_lshlrev_b32 v7, 4, v7
    v_lshl_add_u32 v6, v6, 11, v7
    buffer_load_dwordx4 v[8:11], v6, s[60:63], s6 offen sc1
    s_branch L_hret14
L_fbc_0:
    v_subrev_u32 v40, 131072, v252
    v_lshrrev_b32 v40, 10, v40
    v_and_b32 v41, 31, v1
    v_lshl_add_u32 v40, v40, 5, v41
    v_lshlrev_b32 v40, 2, v40
    v_add_u32 v40, 159744, v40
    ds_read_b32 v41, v40
    s_waitcnt lgkmcnt(0)
    v_sub_f32 v224, 0, v41
    v_sub_f32 v225, 0, v41
    v_sub_f32 v226, 0, v41
    v_sub_f32 v227, 0, v41
    v_sub_f32 v228, 0, v41
    v_sub_f32 v229, 0, v41
    v_sub_f32 v230, 0, v41
    v_sub_f32 v231, 0, v41
    v_sub_f32 v232, 0, v41
    v_sub_f32 v233, 0, v41
    v_sub_f32 v234, 0, v41
    v_sub_f32 v235, 0, v41
    v_sub_f32 v236, 0, v41
    v_sub_f32 v237, 0, v41
    v_sub_f32 v238, 0, v41
    v_sub_f32 v239, 0, v41
    s_nop 1
    v_mfma_f32_32x32x16_bf16 v[128:143], v[64:67], v[248:251], v[224:239]
    s_nop 7
    s_nop 3
    s_branch L_attn
L_fbc_1:
    v_subrev_u32 v40, 131072, v253
    v_lshrrev_b32 v40, 10, v40
    v_and_b32 v41, 31, v1
    v_lshl_add_u32 v40, v40, 5, v41
    v_lshlrev_b32 v40, 2, v40
    v_add_u32 v40, 159744, v40
    ds_read_b32 v41, v40
    s_waitcnt lgkmcnt(0)
    v_sub_f32 v224, 0, v41
    v_sub_f32 v225, 0, v41
    v_sub_f32 v226, 0, v41
    v_sub_f32 v227, 0, v41
    v_sub_f32 v228, 0, v41
    v_sub_f32 v229, 0, v41
    v_sub_f32 v230, 0, v41
    v_sub_f32 v231, 0, v41
    v_sub_f32 v232, 0, v41
    v_sub_f32 v233, 0, v41
    v_sub_f32 v234, 0, v41
    v_sub_f32 v235, 0, v41
    v_sub_f32 v236, 0, v41
    v_sub_f32 v237, 0, v41
    v_sub_f32 v238, 0, v41
    v_sub_f32 v239, 0, v41
    s_nop 1
    s_branch L_fbr_1
L_fbc_2:
    v_subrev_u32 v40, 131072, v254
    v_lshrrev_b32 v40, 10, v40
    v_and_b32 v41, 31, v1
    v_lshl_add_u32 v40, v40, 5, v41
    v_lshlrev_b32 v40, 2, v40
    v_add_u32 v40, 159744, v40
    ds_read_b32 v41, v40
    s_waitcnt lgkmcnt(0)
    v_sub_f32 v224, 0, v41
    v_sub_f32 v225, 0, v41
    v_sub_f32 v226, 0, v41
    v_sub_f32 v227, 0, v41
    v_sub_f32 v228, 0, v41
    v_sub_f32 v229, 0, v41
    v_sub_f32 v230, 0, v41
    v_sub_f32 v231, 0, v41
    v_sub_f32 v232, 0, v41
    v_sub_f32 v233, 0, v41
    v_sub_f32 v234, 0, v41
    v_sub_f32 v235, 0, v41
    v_sub_f32 v236, 0, v41
    v_sub_f32 v237, 0, v41
    v_sub_f32 v238, 0, v41
    v_sub_f32 v239, 0, v41
    s_nop 1
    s_branch L_fbr_2
L_fbc_3:
    v_subrev_u32 v40, 131072, v255
    v_lshrrev_b32 v40, 10, v40
    v_and_b32 v41, 31, v1
    v_lshl_add_u32 v40, v40, 5, v41
    v_lshlrev_b32 v40, 2, v40
    v_add_u32 v40, 159744, v40
    ds_read_b32 v41, v40
    s_waitcnt lgkmcnt(0)
    v_sub_f32 v224, 0, v41
    v_sub_f32 v225, 0, v41
    v_sub_f32 v226, 0, v41
    v_sub_f32 v227, 0, v41
    v_sub_f32 v228, 0, v41
    v_sub_f32 v229, 0, v41
    v_sub_f32 v230, 0, v41
    v_sub_f32 v231, 0, v41
    v_sub_f32 v232, 0, v41
    v_sub_f32 v233, 0, v41
    v_sub_f32 v234, 0, v41
    v_sub_f32 v235, 0, v41
    v_sub_f32 v236, 0, v41
    v_sub_f32 v237, 0, v41
    v_sub_f32 v238, 0, v41
    v_sub_f32 v239, 0, v41
    s_nop 1
    s_branch L_fbr_3
L_fbc_4:
    v_subrev_u32 v40, 131072, v252
    v_lshrrev_b32 v40, 10, v40
    v_and_b32 v41, 31, v1
    v_lshl_add_u32 v40, v40, 5, v41
    v_lshlrev_b32 v40, 2, v40
    v_add_u32 v40, 159744, v40
    ds_read_b32 v41, v40
    s_waitcnt lgkmcnt(0)
    v_sub_f32 v224, 0, v41
    v_sub_f32 v225, 0, v41
    v_sub_f32 v226, 0, v41
    v_sub_f32 v227, 0, v41
    v_sub_f32 v228, 0, v41
    v_sub_f32 v229, 0, v41
    v_sub_f32 v230, 0, v41
    v_sub_f32 v231, 0, v41
    v_sub_f32 v232, 0, v41
    v_sub_f32 v233, 0, v41
    v_sub_f32 v234, 0, v41
    v_sub_f32 v235, 0, v41
    v_sub_f32 v236, 0, v41
    v_sub_f32 v237, 0, v41
    v_sub_f32 v238, 0, v41
    v_sub_f32 v239, 0, v41
    s_nop 1
    s_branch L_fbr_4
L_fbc_5:
    v_subrev_u32 v40, 131072, v253
    v_lshrrev_b32 v40, 10, v40
    v_and_b32 v41, 31, v1
    v_lshl_add_u32 v40, v40, 5, v41
    v_lshlrev_b32 v40, 2, v40
    v_add_u32 v40, 159744, v40
    ds_read_b32 v41, v40
    s_waitcnt lgkmcnt(0)
    v_sub_f32 v224, 0, v41
    v_sub_f32 v225, 0, v41
    v_sub_f32 v226, 0, v41
    v_sub_f32 v227, 0, v41
    v_sub_f32 v228, 0, v41
    v_sub_f32 v229, 0, v41
    v_sub_f32 v230, 0, v41
    v_sub_f32 v231, 0, v41
    v_sub_f32 v232, 0, v41
    v_sub_f32 v233, 0, v41
    v_sub_f32 v234, 0, v41
    v_sub_f32 v235, 0, v41
    v_sub_f32 v236, 0, v41
    v_sub_f32 v237, 0, v41
    v_sub_f32 v238, 0, v41
    v_sub_f32 v239, 0, v41
    s_nop 1
    s_branch L_fbr_5
L_fbc_6:
    v_subrev_u32 v40, 131072, v254
    v_lshrrev_b32 v40, 10, v40
    v_and_b32 v41, 31, v1
    v_lshl_add_u32 v40, v40, 5, v41
    v_lshlrev_b32 v40, 2, v40
    v_add_u32 v40, 159744, v40
    ds_read_b32 v41, v40
    s_waitcnt lgkmcnt(0)
    v_sub_f32 v224, 0, v41
    v_sub_f32 v225, 0, v41
    v_sub_f32 v226, 0, v41
    v_sub_f32 v227, 0, v41
    v_sub_f32 v228, 0, v41
    v_sub_f32 v229, 0, v41
    v_sub_f32 v230, 0, v41
    v_sub_f32 v231, 0, v41
    v_sub_f32 v232, 0, v41
    v_sub_f32 v233, 0, v41
    v_sub_f32 v234, 0, v41
    v_sub_f32 v235, 0, v41
    v_sub_f32 v236, 0, v41
    v_sub_f32 v237, 0, v41
    v_sub_f32 v238, 0, v41
    v_sub_f32 v239, 0, v41
    s_nop 1
    s_branch L_fbr_6
L_fbc_7:
    v_subrev_u32 v40, 131072, v255
    v_lshrrev_b32 v40, 10, v40
    v_and_b32 v41, 31, v1
    v_lshl_add_u32 v40, v40, 5, v41
    v_lshlrev_b32 v40, 2, v40
    v_add_u32 v40, 159744, v40
    ds_read_b32 v41, v40
    s_waitcnt lgkmcnt(0)
    v_sub_f32 v224, 0, v41
    v_sub_f32 v225, 0, v41
    v_sub_f32 v226, 0, v41
    v_sub_f32 v227, 0, v41
    v_sub_f32 v228, 0, v41
    v_sub_f32 v229, 0, v41
    v_sub_f32 v230, 0, v41
    v_sub_f32 v231, 0, v41
    v_sub_f32 v232, 0, v41
    v_sub_f32 v233, 0, v41
    v_sub_f32 v234, 0, v41
    v_sub_f32 v235, 0, v41
    v_sub_f32 v236, 0, v41
    v_sub_f32 v237, 0, v41
    v_sub_f32 v238, 0, v41
    v_sub_f32 v239, 0, v41
    s_nop 1
    s_branch L_fbr_7
L_fallback:
    s_waitcnt vmcnt(0)
    s_mov_b32 s13, 1
    s_mov_b32 s71, 0
    v_and_b32 v40, 31, v1
    v_lshrrev_b32 v41, 5, v1
    v_lshlrev_b32 v26, 5, v40
    v_lshl_add_u32 v26, v41, 4, v26
    v_add_u32 v27, 65536, v5
    s_xor_b32 s7, s28, 0
    buffer_load_dwordx4 v[64:67], v26, s[60:63], s7 offen sc1
    buffer_load_dwordx4 v[96:99], v27, s[60:63], s7 offen sc1
    s_xor_b32 s7, s28, 1024
    buffer_load_dwordx4 v[68:71], v26, s[60:63], s7 offen sc1
    buffer_load_dwordx4 v[100:103], v27, s[60:63], s7 offen sc1
    s_xor_b32 s7, s28, 2048
    buffer_load_dwordx4 v[72:75], v26, s[60:63], s7 offen sc1
    buffer_load_dwordx4 v[104:107], v27, s[60:63], s7 offen sc1
    s_xor_b32 s7, s28, 3072
    buffer_load_dwordx4 v[76:79], v26, s[60:63], s7 offen sc1
    buffer_load_dwordx4 v[108:111], v27, s[60:63], s7 offen sc1
    s_xor_b32 s7, s28, 4096
    buffer_load_dwordx4 v[80:83], v26, s[60:63], s7 offen sc1
    buffer_load_dwordx4 v[112:115], v27, s[60:63], s7 offen sc1
    s_xor_b32 s7, s28, 5120
    buffer_load_dwordx4 v[84:87], v26, s[60:63], s7 offen sc1
    buffer_load_dwordx4 v[116:119], v27, s[60:63], s7 offen sc1
    s_xor_b32 s7, s28, 6144
    buffer_load_dwordx4 v[88:91], v26, s[60:63], s7 offen sc1
    buffer_load_dwordx4 v[120:123], v27, s[60:63], s7 offen sc1
    s_xor_b32 s7, s28, 7168
    buffer_load_dwordx4 v[92:95], v26, s[60:63], s7 offen sc1
    buffer_load_dwordx4 v[124:127], v27, s[60:63], s7 offen sc1
    v_lshlrev_b32 v47, 2, v3
    v_xor_b32 v47, v47, v2
    v_lshlrev_b32 v47, 4, v47
    v_lshl_add_u32 v47, v3, 10, v47
    s_lshr_b32 s6, s5, 1
    s_lshl_b32 s6, s6, 8
    v_add_u32 v47, s6, v47
    s_lshl_b32 s6, s3, 14
    s_lshl_b32 s10, s3, 12
    s_add_u32 m0, s10, 0
    s_add_u32 s7, s6, 0
    buffer_load_dwordx4 v47, s[52:55], s7 offen lds
    s_add_u32 m0, s10, 1024
    s_add_u32 s7, s6, 4096
    buffer_load_dwordx4 v47, s[52:55], s7 offen lds
    s_add_u32 m0, s10, 2048
    s_add_u32 s7, s6, 8192
    buffer_load_dwordx4 v47, s[52:55], s7 offen lds
    s_add_u32 m0, s10, 3072
    s_add_u32 s7, s6, 12288
    buffer_load_dwordx4 v47, s[52:55], s7 offen lds
    v_and_b32 v40, 11, v2
    v_cmp_eq_u32 vcc, 0, v40
    v_mov_b32 v41, 0x3f803f80
    s_nop 7
    v_cndmask_b32 v192, 0, v41, vcc
    v_mov_b32 v193, v192
    v_mov_b32 v194, v192
    v_mov_b32 v195, v192
    v_mov_b32 v196, v192
    v_mov_b32 v197, v192
    v_mov_b32 v198, v192
    v_mov_b32 v199, v192
    v_mov_b32 v200, v192
    v_mov_b32 v201, v192
    v_mov_b32 v202, v192
    v_mov_b32 v203, v192
    v_mov_b32 v204, v192
    v_mov_b32 v205, v192
    v_mov_b32 v206, v192
    v_mov_b32 v207, v192
    v_mov_b32 v208, v192
    v_mov_b32 v209, v192
    v_mov_b32 v210, v192
    v_mov_b32 v211, v192
    v_mov_b32 v212, v192
    v_mov_b32 v213, v192
    v_mov_b32 v214, v192
    v_mov_b32 v215, v192
    v_mov_b32 v216, v192
    v_mov_b32 v217, v192
    v_mov_b32 v218, v192
    v_mov_b32 v219, v192
    v_mov_b32 v220, v192
    v_mov_b32 v221, v192
    v_mov_b32 v222, v192
    v_mov_b32 v223, v192
    v_lshl_or_b32 v40, s3, 6, v1
    v_and_b32 v40, 255, v40
    v_lshlrev_b32 v40, 2, v40
    v_add_u32 v40, 159744, v40
    v_mov_b32 v41, 0xff800000
    ds_write_b32 v40, v41
    v_lshl_or_b32 v46, s3, 6, v1
    v_mov_b32 v44, 0
    v_mov_b32 v45, 0
    v_lshlrev_b32 v46, 3, v46
    v_add_u32 v46, 155648, v46
    ds_write_b64 v46, v[44:45]
    v_xor_b32 v252, 4096, v252
    v_xor_b32 v253, 4096, v253
    v_xor_b32 v254, 4096, v254
    v_xor_b32 v255, 4096, v255
    v_add_u32 v42, 131072, v5
    v_and_b32 v43, 31, v1
    v_lshlrev_b32 v43, 2, v43
    v_add_u32 v43, 159744, v43
    s_mov_b32 s12, 0
    s_waitcnt vmcnt(0) lgkmcnt(0)
    s_barrier
    ds_write_b32 v50, v44
L_fb_loop:
    ds_read_b128 v[248:251], v42
    v_mov_b32 v41, 0xff800000
    s_waitcnt lgkmcnt(0)
    v_mfma_f32_32x32x16_bf16 v[128:143], v[64:67], v[248:251], 0
    s_nop 11
    v_max3_f32 v41, v41, v128, v129
    v_max3_f32 v41, v41, v130, v131
    v_max3_f32 v41, v41, v132, v133
    v_max3_f32 v41, v41, v134, v135
    v_max3_f32 v41, v41, v136, v137
    v_max3_f32 v41, v41, v138, v139
    v_max3_f32 v41, v41, v140, v141
    v_max3_f32 v41, v41, v142, v143
    v_mfma_f32_32x32x16_bf16 v[128:143], v[68:71], v[248:251], 0
    s_nop 11
    v_max3_f32 v41, v41, v128, v129
    v_max3_f32 v41, v41, v130, v131
    v_max3_f32 v41, v41, v132, v133
    v_max3_f32 v41, v41, v134, v135
    v_max3_f32 v41, v41, v136, v137
    v_max3_f32 v41, v41, v138, v139
    v_max3_f32 v41, v41, v140, v141
    v_max3_f32 v41, v41, v142, v143
    v_mfma_f32_32x32x16_bf16 v[128:143], v[72:75], v[248:251], 0
    s_nop 11
    v_max3_f32 v41, v41, v128, v129
    v_max3_f32 v41, v41, v130, v131
    v_max3_f32 v41, v41, v132, v133
    v_max3_f32 v41, v41, v134, v135
    v_max3_f32 v41, v41, v136, v137
    v_max3_f32 v41, v41, v138, v139
    v_max3_f32 v41, v41, v140, v141
    v_max3_f32 v41, v41, v142, v143
    v_mfma_f32_32x32x16_bf16 v[128:143], v[76:79], v[248:251], 0
    s_nop 11
    v_max3_f32 v41, v41, v128, v129
    v_max3_f32 v41, v41, v130, v131
    v_max3_f32 v41, v41, v132, v133
    v_max3_f32 v41, v41, v134, v135
    v_max3_f32 v41, v41, v136, v137
    v_max3_f32 v41, v41, v138, v139
    v_max3_f32 v41, v41, v140, v141
    v_max3_f32 v41, v41, v142, v143
    v_mfma_f32_32x32x16_bf16 v[128:143], v[80:83], v[248:251], 0
    s_nop 11
    v_max3_f32 v41, v41, v128, v129
    v_max3_f32 v41, v41, v130, v131
    v_max3_f32 v41, v41, v132, v133
    v_max3_f32 v41, v41, v134, v135
    v_max3_f32 v41, v41, v136, v137
    v_max3_f32 v41, v41, v138, v139
    v_max3_f32 v41, v41, v140, v141
    v_max3_f32 v41, v41, v142, v143
    v_mfma_f32_32x32x16_bf16 v[128:143], v[84:87], v[248:251], 0
    s_nop 11
    v_max3_f32 v41, v41, v128, v129
    v_max3_f32 v41, v41, v130, v131
    v_max3_f32 v41, v41, v132, v133
    v_max3_f32 v41, v41, v134, v135
    v_max3_f32 v41, v41, v136, v137
    v_max3_f32 v41, v41, v138, v139
    v_max3_f32 v41, v41, v140, v141
    v_max3_f32 v41, v41, v142, v143
    v_mfma_f32_32x32x16_bf16 v[128:143], v[88:91], v[248:251], 0
    s_nop 11
    v_max3_f32 v41, v41, v128, v129
    v_max3_f32 v41, v41, v130, v131
    v_max3_f32 v41, v41, v132, v133
    v_max3_f32 v41, v41, v134, v135
    v_max3_f32 v41, v41, v136, v137
    v_max3_f32 v41, v41, v138, v139
    v_max3_f32 v41, v41, v140, v141
    v_max3_f32 v41, v41, v142, v143
    v_mfma_f32_32x32x16_bf16 v[128:143], v[92:95], v[248:251], 0
    s_nop 11
    v_max3_f32 v41, v41, v128, v129
    v_max3_f32 v41, v41, v130, v131
    v_max3_f32 v41, v41, v132, v133
    v_max3_f32 v41, v41, v134, v135
    v_max3_f32 v41, v41, v136, v137
    v_max3_f32 v41, v41, v138, v139
    v_max3_f32 v41, v41, v140, v141
    v_max3_f32 v41, v41, v142, v143
    ds_max_f32 v43, v41
    v_add_u32 v42, 1024, v42
    v_add_u32 v43, 128, v43
    s_add_u32 s12, s12, 1
    s_cmp_lt_u32 s12, 8
    s_cbranch_scc1 L_fb_loop
    s_waitcnt lgkmcnt(0)
    s_barrier
    ds_read_b128 v[248:251], v252
    s_branch L_fbc_0
L_code_end:
.section .rodata,"a"
.p2align 6
.amdhsa_kernel gated_mix__grouped_kv_mqa__moe_arch_mod__prompt_kernel
  .amdhsa_next_free_vgpr 256
  .amdhsa_next_free_sgpr 102
  .amdhsa_accum_offset 256
  .amdhsa_group_segment_fixed_size 0
  .amdhsa_kernarg_size 112
  .amdhsa_user_sgpr_count 2
  .amdhsa_user_sgpr_kernarg_segment_ptr 1
  .amdhsa_system_sgpr_workgroup_id_x 1
.end_amdhsa_kernel
```
